```python
import torch

def _softmax(x, axis=-1):
    return torch.softmax(x, dim=axis)
def _gelu(x):
    return torch.nn.functional.gelu(x, approximate="tanh")
def _silu(x):
    return torch.nn.functional.silu(x)
def _sigmoid(x):
    return torch.sigmoid(x)
def _layernorm(x, axis=-1, eps=1e-5):
    m = x.mean(dim=axis, keepdim=True)
    v = x.var(dim=axis, keepdim=True, unbiased=False)
    return (x - m) / torch.sqrt(v + eps)
def _scatter_add(tgt, idx, src, axis=0):
    return tgt.clone().index_add_(axis, idx, src)
def _segment_sum(src, seg, n):
    out = torch.zeros((n,) + src.shape[1:], dtype=src.dtype)
    return out.index_add_(0, seg, src)
def _pad(x, pw):
    flat = tuple(v for pair in reversed(pw) for v in pair)
    return torch.nn.functional.pad(x, flat)

kernel_name = 'recurrent_scan__ssm_conv_h3__mixer_s_mlp__prompt'

def setup_inputs():

    _w = (lambda a: (lambda t: t.to(torch.bfloat16) if t.is_floating_point() else t)(torch.as_tensor(a)))
    def _A_setup():
        B, S, D = 1, 2048, 512
        ks = 4
        return {
            "q": _w((lambda *s: torch.randn(*s, dtype=torch.bfloat16) * 0.05)(B, S, D)),
            "k": _w((lambda *s: torch.randn(*s, dtype=torch.bfloat16) * 0.2)(B, S, D)),
            "v": _w((lambda *s: torch.randn(*s, dtype=torch.bfloat16) * 0.2)(B, S, D)),
            "shift_k": _w((lambda *s: torch.randn(*s, dtype=torch.bfloat16) * 0.2)(D, ks) * 0.5),
            "ssm_k": _w((lambda *s: torch.randn(*s, dtype=torch.bfloat16) * 0.2)(D, S) * (1.0 / S ** 0.5)),
            "ssm_D": _w((lambda *s: torch.randn(*s, dtype=torch.bfloat16) * 0.2)(D)),
        }
    _A_in = _A_setup()

    def _B_setup():
        B, S, D, F = 1, 2048, 512, 1792
        return {
            "x":  _w((lambda *s: torch.randn(*s, dtype=torch.bfloat16) * 0.05)(B, S, D)),
            "w1": _w((lambda *s: torch.randn(*s, dtype=torch.bfloat16) * 3.2)(D, D) * (D ** -0.5)),
            "w2": _w((lambda *s: torch.randn(*s, dtype=torch.bfloat16) * 3.2)(D, D) * (D ** -0.5)),
            "w3": _w((lambda *s: torch.randn(*s, dtype=torch.bfloat16) * 3.2)(D, F) * (D ** -0.5)),
            "w4": _w((lambda *s: torch.randn(*s, dtype=torch.bfloat16) * 3.2)(F, D) * (F ** -0.5)),
        }
    _B_in = _B_setup()

    return {
        "A_q": _A_in["q"],
        "A_k": _A_in["k"],
        "A_v": _A_in["v"],
        "A_shift_k": _A_in["shift_k"],
        "A_ssm_k": _A_in["ssm_k"],
        "A_ssm_D": _A_in["ssm_D"],
        "B_x": _B_in["x"],
        "B_w1": _B_in["w1"],
        "B_w2": _B_in["w2"],
        "B_w3": _B_in["w3"],
        "B_w4": _B_in["w4"],
    }

def reference(A_q, A_k, A_v, A_shift_k, A_ssm_k, A_ssm_D, B_x, B_w1, B_w2, B_w3, B_w4):
    def _A_ref(q, k, v, shift_k, ssm_k, ssm_D):
        B, S, D = q.shape
        ks = shift_k.shape[-1]
        k_pad = _pad(k, ((0, 0), (ks - 1, 0), (0, 0)))
        k_shift = torch.zeros_like(k)
        for t in range(ks):
            k_shift = k_shift + k_pad[:, t:t + S, :] * shift_k[:, ks - 1 - t][None, None, :]
        kv = k_shift * v
        L = 2 * S
        kv_pad = _pad(kv, ((0, 0), (0, S), (0, 0)))
        kf_pad = _pad(ssm_k, ((0, 0), (0, S)))
        kv_f = (lambda x, axes=(-2,-1): torch.fft.rfft2(x.float(), dim=axes))(kv_pad[:, None, :, :], axes=(1, 2))
        kf_f = (lambda x, axes=(-2,-1): torch.fft.rfft2(x.float(), dim=axes))(kf_pad[:, None, :], axes=(1, 2))
        kf_f = (lambda x, *d: x.permute(*d))(kf_f, 1, 2, 0)
        y_f = kv_f * kf_f[None, :, :, :]
        y = (lambda x, s, axes=(-2,-1): torch.fft.irfft2(x, s=s, dim=axes).to(torch.bfloat16))(y_f, (1, L), axes=(1, 2))[:, 0, :S, :]
        y = y + kv * ssm_D[None, None, :]
        return q * y

    def _B_ref(x, w1, w2, w3, w4):
        B, S, D = x.shape
        h = _gelu(_layernorm(x, axis=-1) @ w1)
        c = D // 4
        g0 = _pad(h[:, :, 0*c:1*c], ((0, 0), (1, 0), (0, 0)))[:, :S, :]
        g1 = _pad(h[:, :, 1*c:2*c], ((0, 0), (0, 1), (0, 0)))[:, 1:, :]
        g2 = _pad(h[:, :, 2*c:3*c], ((0, 0), (2, 0), (0, 0)))[:, :S, :]
        g3 = _pad(h[:, :, 3*c:   ], ((0, 0), (0, 2), (0, 0)))[:, 2:, :]
        hs = torch.concatenate([g0, g1, g2, g3], axis=-1) @ w2
        x1 = x + hs
        h2 = _gelu(_layernorm(x1, axis=-1) @ w3) @ w4
        return x1 + h2

    x = A_q
    xn = _layernorm(x, axis=-1)
    s = _A_ref(xn, A_k, A_v, A_shift_k, A_ssm_k, A_ssm_D)
    g = _silu(_B_ref(xn, B_w1, B_w2, B_w3, B_w4))
    return x + s * g
```

```asm
; @launch grid=(256,1,1) block=(256,1,1) lds=163840
.amdgcn_target "amdgcn-amd-amdhsa--gfx950"
.text
.globl recurrent_scan__ssm_conv_h3__mixer_s_mlp__prompt_kernel
.p2align 8
.type recurrent_scan__ssm_conv_h3__mixer_s_mlp__prompt_kernel,@function
recurrent_scan__ssm_conv_h3__mixer_s_mlp__prompt_kernel:
    s_cmp_ge_u32 s2, 256
    s_cbranch_scc1 L_end
    s_load_dwordx2 s[4:5], s[0:1], 0
    s_load_dwordx2 s[8:9], s[0:1], 56
    s_load_dwordx2 s[36:37], s[0:1], 104
    s_load_dwordx2 s[32:33], s[0:1], 32
    s_load_dwordx2 s[44:45], s[0:1], 24
    s_load_dwordx2 s[50:51], s[0:1], 40
    s_getpc_b64 s[46:47]
L_pc:
    v_lshrrev_b32 v1, 6, v0
    v_and_b32 v3, 63, v0
    v_readfirstlane_b32 s3, v1
    v_lshrrev_b32 v5, 4, v3
    v_lshrrev_b32 v6, 3, v3
    v_and_b32 v7, 7, v0
    s_mov_b32 s6, 0x200000
    s_mov_b32 s7, 0x20000
    s_mov_b32 s10, 0x80000
    s_mov_b32 s11, 0x20000
    s_and_b32 s56, s2, 7
    s_lshr_b32 s68, s2, 3
    s_and_b32 s58, s68, 3
    s_lshl2_add_u32 s64, s56, s58
    s_lshr_b32 s65, s68, 2
    s_and_b32 s62, s3, 1
    s_lshr_b32 s63, s3, 1
    v_lshlrev_b32 v89, 10, v6
    v_xor_b32 v1, v7, v5
    v_lshlrev_b32 v1, 4, v1
    v_lshl_add_u32 v49, v6, 17, v1
    v_xor_b32 v1, 64, v49
    v_add_u32 v50, 1047552, v1
    v_and_b32 v1, 1, v5
    v_lshlrev_b32 v1, 1, v1
    v_xor_b32 v1, v7, v1
    v_lshl_add_u32 v51, v1, 4, v89
    v_xor_b32 v1, 64, v51
    v_add_u32 v88, 7168, v1
    s_add_u32 s56, s58, s65
    s_lshl_b32 s56, s56, 1
    s_and_b32 s84, s56, 7
    s_lshl_b32 s74, s3, 11
    s_lshl2_add_u32 s77, s64, s3
    s_lshl_b32 s77, s77, 10
    s_lshl_b32 s70, s84, 7
    s_add_u32 s75, s77, s70
    s_lshl2_add_u32 s76, s84, s3
    s_lshl_b32 s76, s76, 7
    s_add_u32 s76, s76, s65
    s_lshl_b32 s76, s76, 7
    s_lshl_b32 s57, s68, 10
    v_lshl_add_u32 v1, v0, 2, s57
    v_min_u32 v1, L_end-L_pc, v1
    global_load_dword v52, v1, s[46:47]
    s_lshl2_add_u32 s58, s65, s3
    s_lshl_b32 s58, s58, 7
    v_lshl_add_u32 v1, v6, 4, s58
    s_lshl1_add_u32 s58, s2, s63
    s_lshl_b32 s58, s58, 12
    s_lshl_b32 s59, s2, 2
    s_mov_b32 s60, 0xf58000
    s_waitcnt lgkmcnt(0)
    s_load_dword s69, s[36:37], s60
    s_load_dword s70, s[32:33], s58
    s_load_dword s71, s[50:51], s59
    s_lshl2_add_u32 s60, s2, s3
    s_min_u32 s60, s60, 383
    s_lshl_b32 s60, s60, 8
    s_add_u32 s60, s60, 0xf40000
    s_load_dword s73, s[36:37], s60
    global_load_dwordx4 v[84:87], v1, s[44:45]
    s_add_u32 m0, s74, 0
    s_nop 0
    buffer_load_dwordx4 v49, s[4:7], s75 offen nt lds
    buffer_load_dwordx4 v50, s[4:7], s75 offen offset:1024 nt lds
    s_add_u32 m0, s74, 65536
    s_nop 0
    buffer_load_dwordx4 v51, s[8:11], s76 offen lds
    buffer_load_dwordx4 v88, s[8:11], s76 offen offset:1024 lds
    s_add_u32 m0, s74, 8192
    s_add_u32 s75, s75, 128
    s_and_b32 s75, s75, 0x380
    s_or_b32 s75, s75, s77
    buffer_load_dwordx4 v49, s[4:7], s75 offen nt lds
    buffer_load_dwordx4 v50, s[4:7], s75 offen offset:1024 nt lds
    s_add_u32 m0, s74, 73728
    s_add_u32 s76, s76, 65536
    s_and_b32 s76, s76, 0x7ffff
    buffer_load_dwordx4 v51, s[8:11], s76 offen lds
    buffer_load_dwordx4 v88, s[8:11], s76 offen offset:1024 lds
    s_load_dwordx2 s[12:13], s[0:1], 8
    s_load_dwordx2 s[16:17], s[0:1], 16
    s_load_dwordx2 s[28:29], s[0:1], 80
    s_load_dwordx2 s[40:41], s[0:1], 88
    s_load_dwordx2 s[20:21], s[0:1], 64
    s_load_dwordx2 s[24:25], s[0:1], 72
    s_mov_b32 s38, 0x1000000
    s_mov_b32 s39, 0x20000
    s_mov_b32 s14, 0x200000
    s_mov_b32 s15, 0x20000
    s_mov_b32 s18, 0x200000
    s_mov_b32 s19, 0x20000
    s_mov_b32 s34, 0x200000
    s_mov_b32 s35, 0x20000
    s_mov_b32 s22, 0x80000
    s_mov_b32 s23, 0x20000
    s_mov_b32 s26, 0x1c0000
    s_mov_b32 s27, 0x20000
    s_mov_b32 s30, 0x1c0000
    s_mov_b32 s31, 0x20000
    s_mov_b32 s42, 0x200000
    s_mov_b32 s43, 0x20000
    s_sub_u32 s56, s65, s84
    s_and_b32 s72, s56, 7
    s_bfe_u32 s56, s2, 0x20001
    s_and_b32 s57, s68, 3
    s_lshl2_add_u32 s66, s56, s57
    s_and_b32 s56, s2, 1
    s_lshl3_add_u32 s67, s56, s65
    v_and_b32 v4, 15, v0
    v_lshlrev_b32 v11, 4, v3
    s_lshl1_add_u32 s58, s63, s62
    s_lshl_b32 s58, s58, 11
    v_lshrrev_b32 v1, 1, v4
    v_xor_b32 v1, v5, v1
    v_lshlrev_b32 v1, 4, v1
    v_lshl_add_u32 v1, v4, 7, v1
    v_add_u32 v90, s58, v1
    v_xor_b32 v91, 64, v90
    v_xor_b32 v92, 0x800, v90
    v_xor_b32 v93, 0x800, v91
    v_lshrrev_b32 v9, 2, v4
    v_lshlrev_b32 v9, 7, v9
    v_and_b32 v10, 3, v4
    v_lshlrev_b32 v10, 3, v10
    v_lshrrev_b32 v1, 3, v4
    v_and_b32 v2, 1, v5
    v_lshl_or_b32 v1, v2, 1, v1
    s_lshl1_add_u32 s58, s62, s63
    v_xor_b32 v1, s58, v1
    v_lshlrev_b32 v1, 5, v1
    v_lshl_add_u32 v1, v5, 10, v1
    v_add3_u32 v1, v1, v9, v10
    v_add_u32 v94, 65536, v1
    v_xor_b32 v95, 32, v94
    v_lshrrev_b32 v1, 3, v4
    v_lshl_add_u32 v8, v5, 1, v1
    v_and_b32 v8, 3, v8
    v_mov_b32 v56, 0x3f803f80
    v_mov_b32 v57, 0x3f803f80
    v_mov_b32 v58, 0x3f803f80
    v_mov_b32 v59, 0x3f803f80
    s_lshl_b32 s58, s64, 16
    s_lshl_b32 s59, s65, 7
    s_add_u32 s58, s58, s59
    s_add_u32 s59, s3, 0
    v_xor_b32 v1, s59, v7
    v_lshl_add_u32 v1, v1, 4, v89
    s_lshl_b32 s60, s59, 13
    s_add_u32 s60, s60, s58
    v_add_u32 v96, s60, v1
    v_subrev_u32 v98, 3072, v96
    s_add_u32 s59, s3, 4
    v_xor_b32 v1, s59, v7
    v_lshl_add_u32 v1, v1, 4, v89
    s_lshl_b32 s60, s59, 13
    s_add_u32 s60, s60, s58
    v_add_u32 v97, s60, v1
    v_subrev_u32 v99, 3072, v97
    v_lshl_add_u32 v1, v7, 4, v89
    s_add_u32 s60, s58, 62464
    v_add_u32 v100, s60, v1
    s_lshr_b32 s58, s65, 2
    s_add_u32 s58, s58, 1
    s_sub_u32 s59, 0, s58
    s_bitcmp1_b32 s65, 1
    s_cselect_b32 s58, s59, s58
    s_lshl2_add_u32 s58, s64, s58
    s_lshl1_add_u32 s58, s63, s58
    s_lshl1_add_u32 s60, s65, s62
    s_xor_b32 s59, s62, 0
    s_add_u32 s53, s59, s58
    s_and_b32 s59, s53, 127
    s_lshl4_add_u32 s59, s59, s60
    s_lshl_b32 s52, s59, 10
    s_xor_b32 s59, s62, 1
    s_add_u32 s55, s59, s58
    s_and_b32 s59, s55, 127
    s_lshl4_add_u32 s59, s59, s60
    s_lshl_b32 s54, s59, 10
    v_lshrrev_b32 v1, 1, v5
    s_lshl_b32 s58, s62, 2
    v_or_b32 v1, s58, v1
    v_lshrrev_b32 v2, 1, v4
    v_xor_b32 v1, v1, v2
    v_lshlrev_b32 v1, 4, v1
    v_and_b32 v2, 1, v5
    v_lshl_or_b32 v1, v2, 3, v1
    v_lshl_add_u32 v1, v4, 7, v1
    s_lshl_b32 s58, s72, 13
    s_lshl_b32 s59, s63, 12
    s_add_u32 s58, s58, s59
    v_add_u32 v101, s58, v1
    v_xor_b32 v102, 32, v101
    s_lshl_b32 s58, s3, 10
    s_add_u32 s58, s58, 151552
    v_add_u32 v103, s58, v11
    v_lshrrev_b32 v1, 2, v4
    v_lshl_add_u32 v1, v1, 4, v4
    v_lshlrev_b32 v1, 4, v1
    v_lshrrev_b32 v2, 1, v10
    v_add3_u32 v104, v1, v2, s58
    s_lshl_b32 s59, s3, 8
    s_add_u32 s59, s59, 159744
    v_lshl_add_u32 v105, v3, 2, s59
    v_xor_b32 v107, 0x400, v104
    v_xor_b32 v108, 0x100, v105
    v_xor_b32 v106, 0x800, v103
    v_xor_b32 v112, 7, v7
    v_lshrrev_b32 v1, 2, v6
    s_lshl_b32 s58, s3, 1
    v_or_b32 v1, s58, v1
    v_and_b32 v2, 3, v6
    v_lshlrev_b32 v2, 2, v2
    v_lshl_add_u32 v2, v112, 10, v2
    v_xor_b32 v109, v1, v112
    v_lshl_add_u32 v109, v109, 4, v2
    v_add_u32 v111, 140288, v109
    v_add_u32 v109, 131072, v109
    v_add_u32 v110, 1, v112
    v_and_b32 v110, 7, v110
    v_xor_b32 v110, v1, v110
    v_lshl_add_u32 v110, v110, 4, v2
    v_add_u32 v110, 132096, v110
    v_lshlrev_b32 v1, 4, v7
    v_lshl_add_u32 v1, v6, 13, v1
    s_lshl_b32 s58, s65, 18
    s_lshl_b32 s59, s3, 16
    s_add_u32 s58, s58, s59
    s_lshl_b32 s59, s64, 7
    s_sub_u32 s58, s58, s59
    s_add_u32 s58, s58, 4198272
    v_add_u32 v112, s58, v1
    v_lshlrev_b32 v1, 1, v5
    v_xor_b32 v1, v7, v1
    v_lshl_add_u32 v19, v1, 4, v89
    v_add_u32 v20, 7168, v19
    v_add_u32 v21, 14336, v19
    v_add_u32 v22, 21504, v19
    s_lshl_b32 s59, s62, 1
    v_xor_b32 v1, s59, v8
    v_lshlrev_b32 v1, 5, v1
    v_lshl_add_u32 v1, v5, 9, v1
    v_add3_u32 v23, v1, v9, v10
    v_xor_b32 v24, 32, v23
    v_xor_b32 v25, 64, v23
    v_xor_b32 v26, 96, v23
    v_add_u32 v1, 0, v3
    v_mul_u32_u24 v2, 4682, v1
    v_lshrrev_b32 v2, 16, v2
    v_lshlrev_b32 v1, 4, v1
    v_mul_u32_u24 v2, 3360, v2
    v_add_u32 v1, v1, v2
    v_subrev_u32 v31, 0, v1
    v_add_u32 v1, 64, v3
    v_mul_u32_u24 v2, 4682, v1
    v_lshrrev_b32 v2, 16, v2
    v_lshlrev_b32 v1, 4, v1
    v_mul_u32_u24 v2, 3360, v2
    v_add_u32 v1, v1, v2
    v_subrev_u32 v32, 1024, v1
    v_add_u32 v1, 128, v3
    v_mul_u32_u24 v2, 4682, v1
    v_lshrrev_b32 v2, 16, v2
    v_lshlrev_b32 v1, 4, v1
    v_mul_u32_u24 v2, 3360, v2
    v_add_u32 v1, v1, v2
    v_subrev_u32 v33, 2048, v1
    v_add_u32 v1, 192, v3
    v_mul_u32_u24 v2, 4682, v1
    v_lshrrev_b32 v2, 16, v2
    v_lshlrev_b32 v1, 4, v1
    v_mul_u32_u24 v2, 3360, v2
    v_add_u32 v1, v1, v2
    v_subrev_u32 v34, 3072, v1
    v_add_u32 v1, 256, v3
    v_mul_u32_u24 v2, 4682, v1
    v_lshrrev_b32 v2, 16, v2
    v_lshlrev_b32 v1, 4, v1
    v_mul_u32_u24 v2, 3360, v2
    v_add_u32 v1, v1, v2
    v_subrev_u32 v35, 0, v1
    v_add_u32 v1, 320, v3
    v_mul_u32_u24 v2, 4682, v1
    v_lshrrev_b32 v2, 16, v2
    v_lshlrev_b32 v1, 4, v1
    v_mul_u32_u24 v2, 3360, v2
    v_add_u32 v1, v1, v2
    v_subrev_u32 v36, 1024, v1
    v_add_u32 v1, 384, v3
    v_mul_u32_u24 v2, 4682, v1
    v_lshrrev_b32 v2, 16, v2
    v_lshlrev_b32 v1, 4, v1
    v_mul_u32_u24 v2, 3360, v2
    v_add_u32 v1, v1, v2
    v_subrev_u32 v37, 2048, v1
    s_mul_i32 s78, s3, 7168
    s_mul_i32 s79, s67, 224
    s_and_b32 s85, s68, 2
    s_lshl1_add_u32 s85, s85, s65
    s_lshl_b32 s85, s85, 1
    s_and_b32 s85, s85, 14
    s_add_u32 s86, s68, s65
    s_and_b32 s86, s86, 1
    s_mul_i32 s80, s62, 14336
    s_mul_i32 s60, s63, 7168
    s_add_u32 s80, s80, s60
    s_mul_i32 s81, s62, 917504
    s_mul_i32 s60, s63, 57344
    s_add_u32 s81, s81, s60
    s_lshl_b32 s60, s65, 7
    s_add_u32 s81, s81, s60
    s_mul_i32 s82, s63, 12864
    s_add_u32 s82, s82, 131072
    s_lshl_b32 s58, s3, 12
    v_add_u32 v14, s58, v11
    v_add_u32 v13, 86016, v14
    v_xor_b32 v14, 0x1000, v14
    v_add_u32 v14, 86016, v14
    s_waitcnt lgkmcnt(0)
    s_mul_i32 s69, s69, 1664525
    s_add_u32 s69, s69, 1013904223
    s_mul_i32 s73, s2, 7168
    s_lshl_b32 s46, s3, 11
    s_add_u32 s73, s73, s46
    buffer_load_dwordx4 v[52:55], v11, s[24:27], s73 offen
    buffer_load_dwordx4 v[52:55], v11, s[24:27], s73 offen offset:1024
    s_lshl_b32 s73, s2, 11
    s_mul_i32 s46, s62, 1024
    s_add_u32 s73, s73, s46
    buffer_load_dwordx4 v[52:55], v11, s[20:23], s73 offen offset:0
    s_add_u32 m0, s74, 16384
    s_add_u32 s75, s75, 128
    s_and_b32 s75, s75, 0x380
    s_or_b32 s75, s75, s77
    buffer_load_dwordx4 v49, s[4:7], s75 offen nt lds
    buffer_load_dwordx4 v50, s[4:7], s75 offen offset:1024 nt lds
    s_add_u32 m0, s74, 81920
    s_add_u32 s76, s76, 65536
    s_and_b32 s76, s76, 0x7ffff
    buffer_load_dwordx4 v51, s[8:11], s76 offen lds
    buffer_load_dwordx4 v88, s[8:11], s76 offen offset:1024 lds
    s_add_u32 m0, s74, 24576
    s_add_u32 s75, s75, 128
    s_and_b32 s75, s75, 0x380
    s_or_b32 s75, s75, s77
    buffer_load_dwordx4 v49, s[4:7], s75 offen nt lds
    buffer_load_dwordx4 v50, s[4:7], s75 offen offset:1024 nt lds
    s_add_u32 m0, s74, 90112
    s_add_u32 s76, s76, 65536
    s_and_b32 s76, s76, 0x7ffff
    buffer_load_dwordx4 v51, s[8:11], s76 offen lds
    buffer_load_dwordx4 v88, s[8:11], s76 offen offset:1024 lds
    s_waitcnt vmcnt(15)
    s_barrier
    ds_read_b128 v[148:151], v90 offset:0
    ds_read_b128 v[152:155], v92 offset:0
    ds_read_b64_tr_b16 v[156:157], v94 offset:0
    ds_read_b64_tr_b16 v[158:159], v94 offset:512
    ds_read_b64_tr_b16 v[160:161], v95 offset:0
    ds_read_b64_tr_b16 v[162:163], v95 offset:512
    ds_read_b128 v[164:167], v91 offset:0
    ds_read_b128 v[168:171], v93 offset:0
    ds_read_b64_tr_b16 v[172:173], v94 offset:4096
    ds_read_b64_tr_b16 v[174:175], v94 offset:4608
    ds_read_b64_tr_b16 v[176:177], v95 offset:4096
    ds_read_b64_tr_b16 v[178:179], v95 offset:4608
    s_waitcnt lgkmcnt(6)
    s_add_u32 m0, s74, 32768
    s_add_u32 s75, s75, 128
    s_and_b32 s75, s75, 0x380
    s_or_b32 s75, s75, s77
    buffer_load_dwordx4 v49, s[4:7], s75 offen nt lds
    v_mfma_f32_16x16x32_bf16 v[144:147], v[148:151], v[148:151], 0
    v_mfma_f32_16x16x32_bf16 v[140:143], v[56:59], v[148:151], 0
    buffer_load_dwordx4 v50, s[4:7], s75 offen offset:1024 nt lds
    v_mfma_f32_16x16x32_bf16 v[116:119], v[156:159], v[148:151], 0
    v_mfma_f32_16x16x32_bf16 v[120:123], v[160:163], v[148:151], 0
    s_add_u32 m0, s74, 98304
    s_add_u32 s76, s76, 65536
    s_and_b32 s76, s76, 0x7ffff
    buffer_load_dwordx4 v51, s[8:11], s76 offen lds
    v_mfma_f32_16x16x32_bf16 v[124:127], v[156:159], v[152:155], 0
    v_mfma_f32_16x16x32_bf16 v[128:131], v[160:163], v[152:155], 0
    buffer_load_dwordx4 v88, s[8:11], s76 offen offset:1024 lds
    v_mfma_f32_16x16x32_bf16 v[132:135], v[156:159], v[56:59], 0
    s_waitcnt lgkmcnt(0)
    s_waitcnt vmcnt(15)
    s_barrier
    ds_read_b128 v[180:183], v90 offset:8192
    ds_read_b128 v[184:187], v92 offset:8192
    v_mfma_f32_16x16x32_bf16 v[144:147], v[164:167], v[164:167], v[144:147]
    ds_read_b64_tr_b16 v[188:189], v94 offset:8192
    ds_read_b64_tr_b16 v[190:191], v94 offset:8704
    v_mfma_f32_16x16x32_bf16 v[140:143], v[56:59], v[164:167], v[140:143]
    ds_read_b64_tr_b16 v[192:193], v95 offset:8192
    ds_read_b64_tr_b16 v[194:195], v95 offset:8704
    v_mfma_f32_16x16x32_bf16 v[116:119], v[172:175], v[164:167], v[116:119]
    ds_read_b128 v[148:151], v91 offset:8192
    v_mfma_f32_16x16x32_bf16 v[120:123], v[176:179], v[164:167], v[120:123]
    ds_read_b128 v[152:155], v93 offset:8192
    ds_read_b64_tr_b16 v[156:157], v94 offset:12288
    v_mfma_f32_16x16x32_bf16 v[124:127], v[172:175], v[168:171], v[124:127]
    ds_read_b64_tr_b16 v[158:159], v94 offset:12800
    ds_read_b64_tr_b16 v[160:161], v95 offset:12288
    v_mfma_f32_16x16x32_bf16 v[128:131], v[176:179], v[168:171], v[128:131]
    ds_read_b64_tr_b16 v[162:163], v95 offset:12800
    s_add_u32 m0, s74, 40960
    s_add_u32 s75, s75, 128
    s_and_b32 s75, s75, 0x380
    s_or_b32 s75, s75, s77
    buffer_load_dwordx4 v49, s[4:7], s75 offen nt lds
    v_mfma_f32_16x16x32_bf16 v[132:135], v[172:175], v[56:59], v[132:135]
    s_waitcnt lgkmcnt(6)
    v_mfma_f32_16x16x32_bf16 v[144:147], v[180:183], v[180:183], v[144:147]
    buffer_load_dwordx4 v50, s[4:7], s75 offen offset:1024 nt lds
    v_mfma_f32_16x16x32_bf16 v[140:143], v[56:59], v[180:183], v[140:143]
    v_mfma_f32_16x16x32_bf16 v[116:119], v[188:191], v[180:183], v[116:119]
    s_add_u32 m0, s74, 106496
    s_add_u32 s76, s76, 65536
    s_and_b32 s76, s76, 0x7ffff
    buffer_load_dwordx4 v51, s[8:11], s76 offen lds
    v_mfma_f32_16x16x32_bf16 v[120:123], v[192:195], v[180:183], v[120:123]
    v_mfma_f32_16x16x32_bf16 v[124:127], v[188:191], v[184:187], v[124:127]
    buffer_load_dwordx4 v88, s[8:11], s76 offen offset:1024 lds
    v_mfma_f32_16x16x32_bf16 v[128:131], v[192:195], v[184:187], v[128:131]
    v_mfma_f32_16x16x32_bf16 v[132:135], v[188:191], v[56:59], v[132:135]
    s_waitcnt lgkmcnt(0)
    s_waitcnt vmcnt(12)
    s_barrier
    ds_read_b128 v[164:167], v90 offset:16384
    ds_read_b128 v[168:171], v92 offset:16384
    v_mfma_f32_16x16x32_bf16 v[144:147], v[148:151], v[148:151], v[144:147]
    ds_read_b64_tr_b16 v[172:173], v94 offset:16384
    ds_read_b64_tr_b16 v[174:175], v94 offset:16896
    v_mfma_f32_16x16x32_bf16 v[140:143], v[56:59], v[148:151], v[140:143]
    ds_read_b64_tr_b16 v[176:177], v95 offset:16384
    ds_read_b64_tr_b16 v[178:179], v95 offset:16896
    v_mfma_f32_16x16x32_bf16 v[116:119], v[156:159], v[148:151], v[116:119]
    ds_read_b128 v[180:183], v91 offset:16384
    v_mfma_f32_16x16x32_bf16 v[120:123], v[160:163], v[148:151], v[120:123]
    ds_read_b128 v[184:187], v93 offset:16384
    ds_read_b64_tr_b16 v[188:189], v94 offset:20480
    v_mfma_f32_16x16x32_bf16 v[124:127], v[156:159], v[152:155], v[124:127]
    ds_read_b64_tr_b16 v[190:191], v94 offset:20992
    ds_read_b64_tr_b16 v[192:193], v95 offset:20480
    v_mfma_f32_16x16x32_bf16 v[128:131], v[160:163], v[152:155], v[128:131]
    ds_read_b64_tr_b16 v[194:195], v95 offset:20992
    s_add_u32 m0, s74, 49152
    s_add_u32 s75, s75, 128
    s_and_b32 s75, s75, 0x380
    s_or_b32 s75, s75, s77
    buffer_load_dwordx4 v49, s[4:7], s75 offen nt lds
    v_mfma_f32_16x16x32_bf16 v[132:135], v[156:159], v[56:59], v[132:135]
    s_waitcnt lgkmcnt(6)
    v_mfma_f32_16x16x32_bf16 v[144:147], v[164:167], v[164:167], v[144:147]
    buffer_load_dwordx4 v50, s[4:7], s75 offen offset:1024 nt lds
    v_mfma_f32_16x16x32_bf16 v[140:143], v[56:59], v[164:167], v[140:143]
    v_mfma_f32_16x16x32_bf16 v[116:119], v[172:175], v[164:167], v[116:119]
    s_add_u32 m0, s74, 114688
    s_add_u32 s76, s76, 65536
    s_and_b32 s76, s76, 0x7ffff
    buffer_load_dwordx4 v51, s[8:11], s76 offen lds
    v_mfma_f32_16x16x32_bf16 v[120:123], v[176:179], v[164:167], v[120:123]
    v_mfma_f32_16x16x32_bf16 v[124:127], v[172:175], v[168:171], v[124:127]
    buffer_load_dwordx4 v88, s[8:11], s76 offen offset:1024 lds
    v_mfma_f32_16x16x32_bf16 v[128:131], v[176:179], v[168:171], v[128:131]
    v_mfma_f32_16x16x32_bf16 v[132:135], v[172:175], v[56:59], v[132:135]
    s_waitcnt lgkmcnt(0)
    s_waitcnt vmcnt(12)
    s_barrier
    ds_read_b128 v[148:151], v90 offset:24576
    ds_read_b128 v[152:155], v92 offset:24576
    v_mfma_f32_16x16x32_bf16 v[144:147], v[180:183], v[180:183], v[144:147]
    ds_read_b64_tr_b16 v[156:157], v94 offset:24576
    ds_read_b64_tr_b16 v[158:159], v94 offset:25088
    v_mfma_f32_16x16x32_bf16 v[140:143], v[56:59], v[180:183], v[140:143]
    ds_read_b64_tr_b16 v[160:161], v95 offset:24576
    ds_read_b64_tr_b16 v[162:163], v95 offset:25088
    v_mfma_f32_16x16x32_bf16 v[116:119], v[188:191], v[180:183], v[116:119]
    ds_read_b128 v[164:167], v91 offset:24576
    v_mfma_f32_16x16x32_bf16 v[120:123], v[192:195], v[180:183], v[120:123]
    ds_read_b128 v[168:171], v93 offset:24576
    ds_read_b64_tr_b16 v[172:173], v94 offset:28672
    v_mfma_f32_16x16x32_bf16 v[124:127], v[188:191], v[184:187], v[124:127]
    ds_read_b64_tr_b16 v[174:175], v94 offset:29184
    ds_read_b64_tr_b16 v[176:177], v95 offset:28672
    v_mfma_f32_16x16x32_bf16 v[128:131], v[192:195], v[184:187], v[128:131]
    ds_read_b64_tr_b16 v[178:179], v95 offset:29184
    s_add_u32 m0, s74, 57344
    s_add_u32 s75, s75, 128
    s_and_b32 s75, s75, 0x380
    s_or_b32 s75, s75, s77
    buffer_load_dwordx4 v49, s[4:7], s75 offen nt lds
    v_mfma_f32_16x16x32_bf16 v[132:135], v[188:191], v[56:59], v[132:135]
    s_waitcnt lgkmcnt(6)
    v_mfma_f32_16x16x32_bf16 v[144:147], v[148:151], v[148:151], v[144:147]
    buffer_load_dwordx4 v50, s[4:7], s75 offen offset:1024 nt lds
    v_mfma_f32_16x16x32_bf16 v[140:143], v[56:59], v[148:151], v[140:143]
    v_mfma_f32_16x16x32_bf16 v[116:119], v[156:159], v[148:151], v[116:119]
    s_add_u32 m0, s74, 122880
    s_add_u32 s76, s76, 65536
    s_and_b32 s76, s76, 0x7ffff
    buffer_load_dwordx4 v51, s[8:11], s76 offen lds
    v_mfma_f32_16x16x32_bf16 v[120:123], v[160:163], v[148:151], v[120:123]
    v_mfma_f32_16x16x32_bf16 v[124:127], v[156:159], v[152:155], v[124:127]
    buffer_load_dwordx4 v88, s[8:11], s76 offen offset:1024 lds
    v_mfma_f32_16x16x32_bf16 v[128:131], v[160:163], v[152:155], v[128:131]
    v_mfma_f32_16x16x32_bf16 v[132:135], v[156:159], v[56:59], v[132:135]
    s_waitcnt lgkmcnt(0)
    s_waitcnt vmcnt(12)
    s_barrier
    ds_read_b128 v[180:183], v90 offset:32768
    ds_read_b128 v[184:187], v92 offset:32768
    v_mfma_f32_16x16x32_bf16 v[144:147], v[164:167], v[164:167], v[144:147]
    ds_read_b64_tr_b16 v[188:189], v94 offset:32768
    ds_read_b64_tr_b16 v[190:191], v94 offset:33280
    v_mfma_f32_16x16x32_bf16 v[140:143], v[56:59], v[164:167], v[140:143]
    ds_read_b64_tr_b16 v[192:193], v95 offset:32768
    ds_read_b64_tr_b16 v[194:195], v95 offset:33280
    v_mfma_f32_16x16x32_bf16 v[116:119], v[172:175], v[164:167], v[116:119]
    ds_read_b128 v[148:151], v91 offset:32768
    v_mfma_f32_16x16x32_bf16 v[120:123], v[176:179], v[164:167], v[120:123]
    ds_read_b128 v[152:155], v93 offset:32768
    ds_read_b64_tr_b16 v[156:157], v94 offset:36864
    v_mfma_f32_16x16x32_bf16 v[124:127], v[172:175], v[168:171], v[124:127]
    ds_read_b64_tr_b16 v[158:159], v94 offset:37376
    ds_read_b64_tr_b16 v[160:161], v95 offset:36864
    v_mfma_f32_16x16x32_bf16 v[128:131], v[176:179], v[168:171], v[128:131]
    ds_read_b64_tr_b16 v[162:163], v95 offset:37376
    s_lshl_b32 s73, s3, 10
    s_add_u32 m0, s73, 131072
    s_nop 0
    buffer_load_dwordx4 v98, s[12:15], 0 offen nt lds
    v_mfma_f32_16x16x32_bf16 v[132:135], v[172:175], v[56:59], v[132:135]
    s_waitcnt lgkmcnt(6)
    v_mfma_f32_16x16x32_bf16 v[144:147], v[180:183], v[180:183], v[144:147]
    s_lshl_b32 s73, s3, 10
    s_add_u32 m0, s73, 135168
    s_nop 0
    buffer_load_dwordx4 v99, s[12:15], 0 offen nt lds
    v_mfma_f32_16x16x32_bf16 v[140:143], v[56:59], v[180:183], v[140:143]
    v_mfma_f32_16x16x32_bf16 v[116:119], v[188:191], v[180:183], v[116:119]
    s_mov_b32 m0, 139264
    s_nop 0
    buffer_load_dwordx4 v100, s[12:15], 0 offen nt lds
    v_mfma_f32_16x16x32_bf16 v[120:123], v[192:195], v[180:183], v[120:123]
    v_mfma_f32_16x16x32_bf16 v[124:127], v[188:191], v[184:187], v[124:127]
    s_lshl_b32 s73, s3, 10
    s_add_u32 m0, s73, 140288
    s_nop 0
    buffer_load_dwordx4 v96, s[16:19], 0 offen nt lds
    v_mfma_f32_16x16x32_bf16 v[128:131], v[192:195], v[184:187], v[128:131]
    v_mfma_f32_16x16x32_bf16 v[132:135], v[188:191], v[56:59], v[132:135]
    s_waitcnt lgkmcnt(0)
    s_waitcnt vmcnt(12)
    s_barrier
    ds_read_b128 v[164:167], v90 offset:40960
    ds_read_b128 v[168:171], v92 offset:40960
    v_mfma_f32_16x16x32_bf16 v[144:147], v[148:151], v[148:151], v[144:147]
    ds_read_b64_tr_b16 v[172:173], v94 offset:40960
    ds_read_b64_tr_b16 v[174:175], v94 offset:41472
    v_mfma_f32_16x16x32_bf16 v[140:143], v[56:59], v[148:151], v[140:143]
    ds_read_b64_tr_b16 v[176:177], v95 offset:40960
    ds_read_b64_tr_b16 v[178:179], v95 offset:41472
    v_mfma_f32_16x16x32_bf16 v[116:119], v[156:159], v[148:151], v[116:119]
    ds_read_b128 v[180:183], v91 offset:40960
    v_mfma_f32_16x16x32_bf16 v[120:123], v[160:163], v[148:151], v[120:123]
    ds_read_b128 v[184:187], v93 offset:40960
    ds_read_b64_tr_b16 v[188:189], v94 offset:45056
    v_mfma_f32_16x16x32_bf16 v[124:127], v[156:159], v[152:155], v[124:127]
    ds_read_b64_tr_b16 v[190:191], v94 offset:45568
    ds_read_b64_tr_b16 v[192:193], v95 offset:45056
    v_mfma_f32_16x16x32_bf16 v[128:131], v[160:163], v[152:155], v[128:131]
    ds_read_b64_tr_b16 v[194:195], v95 offset:45568
    s_lshl_b32 s73, s3, 10
    s_add_u32 m0, s73, 144384
    s_nop 0
    buffer_load_dwordx4 v97, s[16:19], 0 offen nt lds
    v_mfma_f32_16x16x32_bf16 v[132:135], v[156:159], v[56:59], v[132:135]
    s_waitcnt lgkmcnt(6)
    v_mfma_f32_16x16x32_bf16 v[144:147], v[164:167], v[164:167], v[144:147]
    v_mfma_f32_16x16x32_bf16 v[140:143], v[56:59], v[164:167], v[140:143]
    v_mfma_f32_16x16x32_bf16 v[116:119], v[172:175], v[164:167], v[116:119]
    v_mfma_f32_16x16x32_bf16 v[120:123], v[176:179], v[164:167], v[120:123]
    v_mfma_f32_16x16x32_bf16 v[124:127], v[172:175], v[168:171], v[124:127]
    v_mfma_f32_16x16x32_bf16 v[128:131], v[176:179], v[168:171], v[128:131]
    v_mfma_f32_16x16x32_bf16 v[132:135], v[172:175], v[56:59], v[132:135]
    s_waitcnt lgkmcnt(0)
    s_waitcnt vmcnt(9)
    s_barrier
    ds_read_b128 v[148:151], v90 offset:49152
    ds_read_b128 v[152:155], v92 offset:49152
    v_mfma_f32_16x16x32_bf16 v[144:147], v[180:183], v[180:183], v[144:147]
    ds_read_b64_tr_b16 v[156:157], v94 offset:49152
    ds_read_b64_tr_b16 v[158:159], v94 offset:49664
    v_mfma_f32_16x16x32_bf16 v[140:143], v[56:59], v[180:183], v[140:143]
    ds_read_b64_tr_b16 v[160:161], v95 offset:49152
    ds_read_b64_tr_b16 v[162:163], v95 offset:49664
    v_mfma_f32_16x16x32_bf16 v[116:119], v[188:191], v[180:183], v[116:119]
    ds_read_b128 v[164:167], v91 offset:49152
    v_mfma_f32_16x16x32_bf16 v[120:123], v[192:195], v[180:183], v[120:123]
    ds_read_b128 v[168:171], v93 offset:49152
    ds_read_b64_tr_b16 v[172:173], v94 offset:53248
    v_mfma_f32_16x16x32_bf16 v[124:127], v[188:191], v[184:187], v[124:127]
    ds_read_b64_tr_b16 v[174:175], v94 offset:53760
    ds_read_b64_tr_b16 v[176:177], v95 offset:53248
    v_mfma_f32_16x16x32_bf16 v[128:131], v[192:195], v[184:187], v[128:131]
    ds_read_b64_tr_b16 v[178:179], v95 offset:53760
    v_mfma_f32_16x16x32_bf16 v[132:135], v[188:191], v[56:59], v[132:135]
    s_waitcnt lgkmcnt(6)
    v_mfma_f32_16x16x32_bf16 v[144:147], v[148:151], v[148:151], v[144:147]
    v_mfma_f32_16x16x32_bf16 v[140:143], v[56:59], v[148:151], v[140:143]
    v_mfma_f32_16x16x32_bf16 v[116:119], v[156:159], v[148:151], v[116:119]
    v_mfma_f32_16x16x32_bf16 v[120:123], v[160:163], v[148:151], v[120:123]
    v_mfma_f32_16x16x32_bf16 v[124:127], v[156:159], v[152:155], v[124:127]
    v_mfma_f32_16x16x32_bf16 v[128:131], v[160:163], v[152:155], v[128:131]
    v_mfma_f32_16x16x32_bf16 v[132:135], v[156:159], v[56:59], v[132:135]
    s_waitcnt lgkmcnt(0)
    s_waitcnt vmcnt(5)
    s_barrier
    ds_read_b128 v[180:183], v90 offset:57344
    ds_read_b128 v[184:187], v92 offset:57344
    v_mfma_f32_16x16x32_bf16 v[144:147], v[164:167], v[164:167], v[144:147]
    ds_read_b64_tr_b16 v[188:189], v94 offset:57344
    ds_read_b64_tr_b16 v[190:191], v94 offset:57856
    v_mfma_f32_16x16x32_bf16 v[140:143], v[56:59], v[164:167], v[140:143]
    ds_read_b64_tr_b16 v[192:193], v95 offset:57344
    ds_read_b64_tr_b16 v[194:195], v95 offset:57856
    v_mfma_f32_16x16x32_bf16 v[116:119], v[172:175], v[164:167], v[116:119]
    ds_read_b128 v[148:151], v91 offset:57344
    v_mfma_f32_16x16x32_bf16 v[120:123], v[176:179], v[164:167], v[120:123]
    ds_read_b128 v[152:155], v93 offset:57344
    ds_read_b64_tr_b16 v[156:157], v94 offset:61440
    v_mfma_f32_16x16x32_bf16 v[124:127], v[172:175], v[168:171], v[124:127]
    ds_read_b64_tr_b16 v[158:159], v94 offset:61952
    ds_read_b64_tr_b16 v[160:161], v95 offset:61440
    v_mfma_f32_16x16x32_bf16 v[128:131], v[176:179], v[168:171], v[128:131]
    ds_read_b64_tr_b16 v[162:163], v95 offset:61952
    v_mfma_f32_16x16x32_bf16 v[132:135], v[172:175], v[56:59], v[132:135]
    s_waitcnt lgkmcnt(6)
    v_mfma_f32_16x16x32_bf16 v[144:147], v[180:183], v[180:183], v[144:147]
    v_mfma_f32_16x16x32_bf16 v[140:143], v[56:59], v[180:183], v[140:143]
    v_mfma_f32_16x16x32_bf16 v[116:119], v[188:191], v[180:183], v[116:119]
    v_mfma_f32_16x16x32_bf16 v[120:123], v[192:195], v[180:183], v[120:123]
    v_mfma_f32_16x16x32_bf16 v[124:127], v[188:191], v[184:187], v[124:127]
    v_mfma_f32_16x16x32_bf16 v[128:131], v[192:195], v[184:187], v[128:131]
    v_mfma_f32_16x16x32_bf16 v[132:135], v[188:191], v[56:59], v[132:135]
    s_waitcnt lgkmcnt(0)
    ds_read_b64 v[60:61], v101 offset:0
    ds_read_b64 v[62:63], v102 offset:0
    ds_read_b64 v[64:65], v101 offset:2048
    ds_read_b64 v[66:67], v102 offset:2048
    v_mfma_f32_16x16x32_bf16 v[144:147], v[148:151], v[148:151], v[144:147]
    v_mfma_f32_16x16x32_bf16 v[140:143], v[56:59], v[148:151], v[140:143]
    v_mfma_f32_16x16x32_bf16 v[116:119], v[156:159], v[148:151], v[116:119]
    v_mfma_f32_16x16x32_bf16 v[120:123], v[160:163], v[148:151], v[120:123]
    v_mfma_f32_16x16x32_bf16 v[124:127], v[156:159], v[152:155], v[124:127]
    v_mfma_f32_16x16x32_bf16 v[128:131], v[160:163], v[152:155], v[128:131]
    v_mfma_f32_16x16x32_bf16 v[132:135], v[156:159], v[56:59], v[132:135]
    s_nop 1
    ds_write_b128 v103, v[144:147] offset:4096
    ds_write_b32 v105, v140
    s_nop 3
    ds_write_b128 v103, v[132:135]
    s_waitcnt lgkmcnt(0)
    s_barrier
    ds_read_b32 v196, v104 offset:4096
    ds_read_b32 v197, v107 offset:4096
    ds_read_b32 v115, v108
    ds_read_b128 v[136:139], v106
    s_lshl_b32 s73, s3, 14
    s_add_u32 m0, s73, 65536
    s_lshl2_add_u32 s73, s62, s84
    s_add_u32 s73, s73, 0
    s_and_b32 s73, s73, 7
    s_lshl3_add_u32 s73, s63, s73
    s_lshl_b32 s73, s73, 8
    s_add_u32 s73, s73, s65
    s_lshl_b32 s73, s73, 7
    buffer_load_dwordx4 v19, s[20:23], s73 offen offset:0 lds
    v_mov_b32 v114, v140
    s_waitcnt lgkmcnt(1)
    s_mov_b32 s48, 0x3b000000
    v_pk_mul_f32 v[198:199], v[114:115], s[48:49] op_sel:[0,0] op_sel_hi:[1,0]
    v_pk_mul_f32 v[200:201], v[198:199], v[198:199] op_sel:[0,0] op_sel_hi:[1,1]
    v_pk_fma_f32 v[200:201], v[196:197], s[48:49], v[200:201] op_sel:[0,0,0] op_sel_hi:[1,0,1] neg_lo:[0,0,1] neg_hi:[0,0,1]
    v_max_f32 v200, 0, v200
    v_max_f32 v201, 0, v201
    s_mov_b32 s48, 0x3727c5ac
    v_cvt_pk_bf16_f32 v1, v198, v199
    v_lshlrev_b32 v202, 16, v1
    v_and_b32 v203, 0xffff0000, v1
    v_cvt_pk_bf16_f32 v2, v200, v201
    v_lshlrev_b32 v206, 16, v2
    v_and_b32 v207, 0xffff0000, v2
    v_pk_add_f32 v[206:207], v[206:207], s[48:49] op_sel:[0,0] op_sel_hi:[1,0]
    buffer_load_dwordx4 v20, s[20:23], s73 offen offset:1024 lds
    v_cvt_pk_bf16_f32 v2, v206, v207
    v_lshlrev_b32 v206, 16, v2
    v_and_b32 v207, 0xffff0000, v2
    v_sqrt_f32 v206, v206
    v_sqrt_f32 v207, v207
    s_nop 0
    v_cvt_pk_bf16_f32 v2, v206, v207
    v_lshlrev_b32 v206, 16, v2
    v_and_b32 v207, 0xffff0000, v2
    v_rcp_f32 v204, v206
    v_rcp_f32 v205, v207
    v_pk_add_f32 v[198:199], v[198:199], v[202:203] op_sel:[0,0] op_sel_hi:[1,1] neg_lo:[0,1] neg_hi:[0,1]
    v_pk_mul_f32 v[200:201], v[200:201], v[204:205] op_sel:[0,0] op_sel_hi:[1,1]
    buffer_load_dwordx4 v21, s[20:23], s73 offen offset:2048 lds
    v_pk_mul_f32 v[198:199], v[198:199], v[204:205] op_sel:[0,0] op_sel_hi:[1,1]
    v_pk_mul_f32 v[200:201], v[200:201], v[204:205] op_sel:[0,0] op_sel_hi:[1,1]
    v_cvt_pk_bf16_f32 v1, v198, v199
    v_lshlrev_b32 v198, 16, v1
    v_and_b32 v199, 0xffff0000, v1
    v_cvt_pk_bf16_f32 v2, v200, v201
    v_lshlrev_b32 v210, 16, v2
    v_and_b32 v211, 0xffff0000, v2
    v_pk_add_f32 v[210:211], v[210:211], s[48:49] op_sel:[0,0] op_sel_hi:[1,0]
    v_cvt_pk_bf16_f32 v2, v210, v211
    v_lshlrev_b32 v210, 16, v2
    v_and_b32 v211, 0xffff0000, v2
    v_sqrt_f32 v210, v210
    v_sqrt_f32 v211, v211
    buffer_load_dwordx4 v22, s[20:23], s73 offen offset:3072 lds
    v_cvt_pk_bf16_f32 v2, v210, v211
    v_lshlrev_b32 v210, 16, v2
    v_and_b32 v211, 0xffff0000, v2
    v_pk_fma_f32 v[208:209], v[198:199], v[206:207], v[202:203] op_sel:[0,0,0] op_sel_hi:[1,1,1]
    v_pk_mul_f32 v[210:211], v[210:211], v[206:207] op_sel:[0,0] op_sel_hi:[1,1]
    v_rcp_f32 v212, v210
    v_rcp_f32 v213, v211
    s_mov_b32 s48, 0xc0135761
    s_mov_b32 s50, 0x3d372713
    v_pk_mul_f32 v[214:215], v[212:213], v[212:213] op_sel:[0,0] op_sel_hi:[1,1]
    v_pk_mul_f32 v[212:213], v[212:213], s[48:49] op_sel:[0,0] op_sel_hi:[1,0]
    v_pk_mul_f32 v[214:215], v[214:215], s[50:51] op_sel:[0,0] op_sel_hi:[1,0]
    v_pk_mul_f32 v[214:215], v[214:215], v[212:213] op_sel:[0,0] op_sel_hi:[1,1]
    s_waitcnt lgkmcnt(0)
    v_pk_fma_f32 v[116:117], v[208:209], v[132:133], v[116:117] op_sel:[0,0,0] op_sel_hi:[0,1,1] neg_lo:[1,0,0] neg_hi:[1,0,0]
    v_pk_fma_f32 v[118:119], v[208:209], v[134:135], v[118:119] op_sel:[0,0,0] op_sel_hi:[0,1,1] neg_lo:[1,0,0] neg_hi:[1,0,0]
    v_pk_fma_f32 v[120:121], v[208:209], v[136:137], v[120:121] op_sel:[0,0,0] op_sel_hi:[0,1,1] neg_lo:[1,0,0] neg_hi:[1,0,0]
    v_pk_fma_f32 v[122:123], v[208:209], v[138:139], v[122:123] op_sel:[0,0,0] op_sel_hi:[0,1,1] neg_lo:[1,0,0] neg_hi:[1,0,0]
    v_pk_fma_f32 v[124:125], v[208:209], v[132:133], v[124:125] op_sel:[1,0,0] op_sel_hi:[1,1,1] neg_lo:[1,0,0] neg_hi:[1,0,0]
    v_pk_fma_f32 v[126:127], v[208:209], v[134:135], v[126:127] op_sel:[1,0,0] op_sel_hi:[1,1,1] neg_lo:[1,0,0] neg_hi:[1,0,0]
    v_pk_fma_f32 v[128:129], v[208:209], v[136:137], v[128:129] op_sel:[1,0,0] op_sel_hi:[1,1,1] neg_lo:[1,0,0] neg_hi:[1,0,0]
    v_pk_fma_f32 v[130:131], v[208:209], v[138:139], v[130:131] op_sel:[1,0,0] op_sel_hi:[1,1,1] neg_lo:[1,0,0] neg_hi:[1,0,0]
    v_pk_mul_f32 v[216:217], v[116:117], v[116:117] op_sel:[0,0] op_sel_hi:[1,1]
    v_pk_mul_f32 v[218:219], v[118:119], v[118:119] op_sel:[0,0] op_sel_hi:[1,1]
    v_pk_mul_f32 v[220:221], v[120:121], v[120:121] op_sel:[0,0] op_sel_hi:[1,1]
    v_pk_mul_f32 v[222:223], v[122:123], v[122:123] op_sel:[0,0] op_sel_hi:[1,1]
    v_pk_mul_f32 v[224:225], v[124:125], v[124:125] op_sel:[0,0] op_sel_hi:[1,1]
    v_pk_mul_f32 v[226:227], v[126:127], v[126:127] op_sel:[0,0] op_sel_hi:[1,1]
    v_pk_mul_f32 v[228:229], v[128:129], v[128:129] op_sel:[0,0] op_sel_hi:[1,1]
    v_pk_mul_f32 v[230:231], v[130:131], v[130:131] op_sel:[0,0] op_sel_hi:[1,1]
    v_pk_fma_f32 v[216:217], v[216:217], v[214:215], v[212:213] op_sel:[0,0,0] op_sel_hi:[1,0,0]
    v_pk_fma_f32 v[218:219], v[218:219], v[214:215], v[212:213] op_sel:[0,0,0] op_sel_hi:[1,0,0]
    v_pk_fma_f32 v[220:221], v[220:221], v[214:215], v[212:213] op_sel:[0,0,0] op_sel_hi:[1,0,0]
    v_pk_fma_f32 v[222:223], v[222:223], v[214:215], v[212:213] op_sel:[0,0,0] op_sel_hi:[1,0,0]
    v_pk_fma_f32 v[224:225], v[224:225], v[214:215], v[212:213] op_sel:[0,1,1] op_sel_hi:[1,1,1]
    v_pk_fma_f32 v[226:227], v[226:227], v[214:215], v[212:213] op_sel:[0,1,1] op_sel_hi:[1,1,1]
    v_pk_fma_f32 v[228:229], v[228:229], v[214:215], v[212:213] op_sel:[0,1,1] op_sel_hi:[1,1,1]
    v_pk_fma_f32 v[230:231], v[230:231], v[214:215], v[212:213] op_sel:[0,1,1] op_sel_hi:[1,1,1]
    v_pk_mul_f32 v[216:217], v[216:217], v[116:117] op_sel:[0,0] op_sel_hi:[1,1]
    v_pk_mul_f32 v[218:219], v[218:219], v[118:119] op_sel:[0,0] op_sel_hi:[1,1]
    v_pk_mul_f32 v[220:221], v[220:221], v[120:121] op_sel:[0,0] op_sel_hi:[1,1]
    v_pk_mul_f32 v[222:223], v[222:223], v[122:123] op_sel:[0,0] op_sel_hi:[1,1]
    v_pk_mul_f32 v[224:225], v[224:225], v[124:125] op_sel:[0,0] op_sel_hi:[1,1]
    v_pk_mul_f32 v[226:227], v[226:227], v[126:127] op_sel:[0,0] op_sel_hi:[1,1]
    v_pk_mul_f32 v[228:229], v[228:229], v[128:129] op_sel:[0,0] op_sel_hi:[1,1]
    v_pk_mul_f32 v[230:231], v[230:231], v[130:131] op_sel:[0,0] op_sel_hi:[1,1]
    v_exp_f32 v216, v216
    v_exp_f32 v217, v217
    v_exp_f32 v218, v218
    v_exp_f32 v219, v219
    v_exp_f32 v220, v220
    v_exp_f32 v221, v221
    v_exp_f32 v222, v222
    v_exp_f32 v223, v223
    v_exp_f32 v224, v224
    v_exp_f32 v225, v225
    v_exp_f32 v226, v226
    v_exp_f32 v227, v227
    v_exp_f32 v228, v228
    v_exp_f32 v229, v229
    v_exp_f32 v230, v230
    v_exp_f32 v231, v231
    v_pk_fma_f32 v[216:217], v[216:217], v[210:211], v[210:211] op_sel:[0,0,0] op_sel_hi:[1,0,0]
    v_pk_fma_f32 v[218:219], v[218:219], v[210:211], v[210:211] op_sel:[0,0,0] op_sel_hi:[1,0,0]
    v_pk_fma_f32 v[220:221], v[220:221], v[210:211], v[210:211] op_sel:[0,0,0] op_sel_hi:[1,0,0]
    v_pk_fma_f32 v[222:223], v[222:223], v[210:211], v[210:211] op_sel:[0,0,0] op_sel_hi:[1,0,0]
    v_pk_fma_f32 v[224:225], v[224:225], v[210:211], v[210:211] op_sel:[0,1,1] op_sel_hi:[1,1,1]
    v_pk_fma_f32 v[226:227], v[226:227], v[210:211], v[210:211] op_sel:[0,1,1] op_sel_hi:[1,1,1]
    v_pk_fma_f32 v[228:229], v[228:229], v[210:211], v[210:211] op_sel:[0,1,1] op_sel_hi:[1,1,1]
    v_pk_fma_f32 v[230:231], v[230:231], v[210:211], v[210:211] op_sel:[0,1,1] op_sel_hi:[1,1,1]
    v_rcp_f32 v216, v216
    v_rcp_f32 v217, v217
    v_rcp_f32 v218, v218
    v_rcp_f32 v219, v219
    v_rcp_f32 v220, v220
    v_rcp_f32 v221, v221
    v_rcp_f32 v222, v222
    v_rcp_f32 v223, v223
    v_rcp_f32 v224, v224
    v_rcp_f32 v225, v225
    v_rcp_f32 v226, v226
    v_rcp_f32 v227, v227
    v_rcp_f32 v228, v228
    v_rcp_f32 v229, v229
    v_rcp_f32 v230, v230
    v_rcp_f32 v231, v231
    v_pk_mul_f32 v[216:217], v[216:217], v[116:117] op_sel:[0,0] op_sel_hi:[1,1]
    v_pk_mul_f32 v[218:219], v[218:219], v[118:119] op_sel:[0,0] op_sel_hi:[1,1]
    v_pk_mul_f32 v[220:221], v[220:221], v[120:121] op_sel:[0,0] op_sel_hi:[1,1]
    v_pk_mul_f32 v[222:223], v[222:223], v[122:123] op_sel:[0,0] op_sel_hi:[1,1]
    v_pk_mul_f32 v[224:225], v[224:225], v[124:125] op_sel:[0,0] op_sel_hi:[1,1]
    v_pk_mul_f32 v[226:227], v[226:227], v[126:127] op_sel:[0,0] op_sel_hi:[1,1]
    v_pk_mul_f32 v[228:229], v[228:229], v[128:129] op_sel:[0,0] op_sel_hi:[1,1]
    v_pk_mul_f32 v[230:231], v[230:231], v[130:131] op_sel:[0,0] op_sel_hi:[1,1]
    v_cvt_pk_bf16_f32 v232, v216, v217
    v_cvt_pk_bf16_f32 v233, v218, v219
    v_cvt_pk_bf16_f32 v234, v220, v221
    v_cvt_pk_bf16_f32 v235, v222, v223
    v_cvt_pk_bf16_f32 v236, v224, v225
    v_cvt_pk_bf16_f32 v237, v226, v227
    v_cvt_pk_bf16_f32 v238, v228, v229
    v_cvt_pk_bf16_f32 v239, v230, v231
    s_cmp_eq_u32 s63, 1
    s_cbranch_scc0 L_skip_1
    v_swap_b32 v232, v234
    v_swap_b32 v233, v235
    v_swap_b32 v236, v238
    v_swap_b32 v237, v239
L_skip_1:
    s_cmp_gt_i32 s53, 127
    s_cbranch_scc0 L_skip_2
    v_mov_b32_dpp v232, v232 row_shr:1 row_mask:0xf bank_mask:0xf bound_ctrl:1
    v_mov_b32_dpp v233, v233 row_shr:1 row_mask:0xf bank_mask:0xf bound_ctrl:1
    v_mov_b32_dpp v234, v234 row_shr:1 row_mask:0xf bank_mask:0xf bound_ctrl:1
    v_mov_b32_dpp v235, v235 row_shr:1 row_mask:0xf bank_mask:0xf bound_ctrl:1
L_skip_2:
    s_cmp_lt_i32 s53, 0
    s_cbranch_scc0 L_skip_3
    v_mov_b32_dpp v232, v232 row_shl:1 row_mask:0xf bank_mask:0xf bound_ctrl:1
    v_mov_b32_dpp v233, v233 row_shl:1 row_mask:0xf bank_mask:0xf bound_ctrl:1
    v_mov_b32_dpp v234, v234 row_shl:1 row_mask:0xf bank_mask:0xf bound_ctrl:1
    v_mov_b32_dpp v235, v235 row_shl:1 row_mask:0xf bank_mask:0xf bound_ctrl:1
L_skip_3:
    buffer_store_dwordx4 v[232:235], v11, s[36:39], s52 offen sc1
    s_cmp_gt_i32 s55, 127
    s_cbranch_scc0 L_skip_4
    v_mov_b32_dpp v236, v236 row_shr:1 row_mask:0xf bank_mask:0xf bound_ctrl:1
    v_mov_b32_dpp v237, v237 row_shr:1 row_mask:0xf bank_mask:0xf bound_ctrl:1
    v_mov_b32_dpp v238, v238 row_shr:1 row_mask:0xf bank_mask:0xf bound_ctrl:1
    v_mov_b32_dpp v239, v239 row_shr:1 row_mask:0xf bank_mask:0xf bound_ctrl:1
L_skip_4:
    s_cmp_lt_i32 s55, 0
    s_cbranch_scc0 L_skip_5
    v_mov_b32_dpp v236, v236 row_shl:1 row_mask:0xf bank_mask:0xf bound_ctrl:1
    v_mov_b32_dpp v237, v237 row_shl:1 row_mask:0xf bank_mask:0xf bound_ctrl:1
    v_mov_b32_dpp v238, v238 row_shl:1 row_mask:0xf bank_mask:0xf bound_ctrl:1
    v_mov_b32_dpp v239, v239 row_shl:1 row_mask:0xf bank_mask:0xf bound_ctrl:1
L_skip_5:
    buffer_store_dwordx4 v[236:239], v11, s[36:39], s54 offen sc1
    s_waitcnt vmcnt(6)
    s_barrier
    ds_read2_b32 v[88:89], v109 offset0:0 offset1:32
    ds_read2_b32 v[90:91], v109 offset0:64 offset1:96
    ds_read2_b32 v[92:93], v109 offset0:128 offset1:160
    ds_read2_b32 v[94:95], v109 offset0:192 offset1:224
    ds_read2_b32 v[96:97], v110 offset0:0 offset1:32
    ds_read_b32 v98, v110 offset:256
    ds_read2_b32 v[100:101], v111 offset0:0 offset1:32
    ds_read2_b32 v[102:103], v111 offset0:64 offset1:96
    ds_read2_b32 v[104:105], v111 offset0:128 offset1:160
    ds_read2_b32 v[106:107], v111 offset0:192 offset1:224
    v_lshlrev_b32 v138, 16, v84
    v_and_b32 v140, 0xffff0000, v84
    v_lshlrev_b32 v142, 16, v85
    v_and_b32 v144, 0xffff0000, v85
    v_lshlrev_b32 v139, 16, v86
    v_and_b32 v141, 0xffff0000, v86
    v_lshlrev_b32 v143, 16, v87
    v_and_b32 v145, 0xffff0000, v87
    s_waitcnt lgkmcnt(4)
    v_lshlrev_b32 v116, 16, v88
    s_lshl_b32 s73, s3, 14
    s_add_u32 m0, s73, 69632
    s_lshl2_add_u32 s73, s62, s84
    s_add_u32 s73, s73, 1
    s_and_b32 s73, s73, 7
    s_lshl3_add_u32 s73, s63, s73
    s_lshl_b32 s73, s73, 8
    s_add_u32 s73, s73, s65
    s_lshl_b32 s73, s73, 7
    buffer_load_dwordx4 v19, s[20:23], s73 offen offset:0 lds
    v_and_b32 v117, 0xffff0000, v88
    v_lshlrev_b32 v118, 16, v89
    v_and_b32 v119, 0xffff0000, v89
    v_lshlrev_b32 v120, 16, v90
    v_and_b32 v121, 0xffff0000, v90
    v_lshlrev_b32 v122, 16, v91
    v_and_b32 v123, 0xffff0000, v91
    v_lshlrev_b32 v124, 16, v92
    v_and_b32 v125, 0xffff0000, v92
    v_lshlrev_b32 v126, 16, v93
    v_and_b32 v127, 0xffff0000, v93
    v_lshlrev_b32 v128, 16, v94
    v_and_b32 v129, 0xffff0000, v94
    v_lshlrev_b32 v130, 16, v95
    v_and_b32 v131, 0xffff0000, v95
    v_lshlrev_b32 v132, 16, v96
    buffer_load_dwordx4 v20, s[20:23], s73 offen offset:1024 lds
    v_and_b32 v133, 0xffff0000, v96
    v_lshlrev_b32 v134, 16, v97
    v_and_b32 v135, 0xffff0000, v97
    v_lshlrev_b32 v136, 16, v98
    v_and_b32 v137, 0xffff0000, v98
    v_pk_mul_f32 v[146:147], v[116:117], v[144:145] op_sel:[0,0] op_sel_hi:[1,1]
    v_pk_mul_f32 v[148:149], v[118:119], v[144:145] op_sel:[0,0] op_sel_hi:[1,1]
    v_pk_mul_f32 v[150:151], v[120:121], v[144:145] op_sel:[0,0] op_sel_hi:[1,1]
    v_pk_mul_f32 v[152:153], v[122:123], v[144:145] op_sel:[0,0] op_sel_hi:[1,1]
    v_pk_mul_f32 v[154:155], v[124:125], v[144:145] op_sel:[0,0] op_sel_hi:[1,1]
    v_pk_mul_f32 v[156:157], v[126:127], v[144:145] op_sel:[0,0] op_sel_hi:[1,1]
    v_pk_mul_f32 v[158:159], v[128:129], v[144:145] op_sel:[0,0] op_sel_hi:[1,1]
    v_pk_mul_f32 v[160:161], v[130:131], v[144:145] op_sel:[0,0] op_sel_hi:[1,1]
    v_pk_fma_f32 v[146:147], v[118:119], v[142:143], v[146:147] op_sel:[0,0,0] op_sel_hi:[1,1,1]
    buffer_load_dwordx4 v21, s[20:23], s73 offen offset:2048 lds
    v_pk_fma_f32 v[148:149], v[120:121], v[142:143], v[148:149] op_sel:[0,0,0] op_sel_hi:[1,1,1]
    v_pk_fma_f32 v[150:151], v[122:123], v[142:143], v[150:151] op_sel:[0,0,0] op_sel_hi:[1,1,1]
    v_pk_fma_f32 v[152:153], v[124:125], v[142:143], v[152:153] op_sel:[0,0,0] op_sel_hi:[1,1,1]
    v_pk_fma_f32 v[154:155], v[126:127], v[142:143], v[154:155] op_sel:[0,0,0] op_sel_hi:[1,1,1]
    v_pk_fma_f32 v[156:157], v[128:129], v[142:143], v[156:157] op_sel:[0,0,0] op_sel_hi:[1,1,1]
    v_pk_fma_f32 v[158:159], v[130:131], v[142:143], v[158:159] op_sel:[0,0,0] op_sel_hi:[1,1,1]
    v_pk_fma_f32 v[160:161], v[132:133], v[142:143], v[160:161] op_sel:[0,0,0] op_sel_hi:[1,1,1]
    v_pk_fma_f32 v[146:147], v[120:121], v[140:141], v[146:147] op_sel:[0,0,0] op_sel_hi:[1,1,1]
    v_pk_fma_f32 v[148:149], v[122:123], v[140:141], v[148:149] op_sel:[0,0,0] op_sel_hi:[1,1,1]
    v_pk_fma_f32 v[150:151], v[124:125], v[140:141], v[150:151] op_sel:[0,0,0] op_sel_hi:[1,1,1]
    v_pk_fma_f32 v[152:153], v[126:127], v[140:141], v[152:153] op_sel:[0,0,0] op_sel_hi:[1,1,1]
    v_pk_fma_f32 v[154:155], v[128:129], v[140:141], v[154:155] op_sel:[0,0,0] op_sel_hi:[1,1,1]
    v_pk_fma_f32 v[156:157], v[130:131], v[140:141], v[156:157] op_sel:[0,0,0] op_sel_hi:[1,1,1]
    buffer_load_dwordx4 v22, s[20:23], s73 offen offset:3072 lds
    v_pk_fma_f32 v[158:159], v[132:133], v[140:141], v[158:159] op_sel:[0,0,0] op_sel_hi:[1,1,1]
    v_pk_fma_f32 v[160:161], v[134:135], v[140:141], v[160:161] op_sel:[0,0,0] op_sel_hi:[1,1,1]
    v_pk_fma_f32 v[146:147], v[122:123], v[138:139], v[146:147] op_sel:[0,0,0] op_sel_hi:[1,1,1]
    v_pk_fma_f32 v[148:149], v[124:125], v[138:139], v[148:149] op_sel:[0,0,0] op_sel_hi:[1,1,1]
    v_pk_fma_f32 v[150:151], v[126:127], v[138:139], v[150:151] op_sel:[0,0,0] op_sel_hi:[1,1,1]
    v_pk_fma_f32 v[152:153], v[128:129], v[138:139], v[152:153] op_sel:[0,0,0] op_sel_hi:[1,1,1]
    v_pk_fma_f32 v[154:155], v[130:131], v[138:139], v[154:155] op_sel:[0,0,0] op_sel_hi:[1,1,1]
    v_pk_fma_f32 v[156:157], v[132:133], v[138:139], v[156:157] op_sel:[0,0,0] op_sel_hi:[1,1,1]
    v_pk_fma_f32 v[158:159], v[134:135], v[138:139], v[158:159] op_sel:[0,0,0] op_sel_hi:[1,1,1]
    v_pk_fma_f32 v[160:161], v[136:137], v[138:139], v[160:161] op_sel:[0,0,0] op_sel_hi:[1,1,1]
    s_waitcnt lgkmcnt(0)
    v_lshlrev_b32 v116, 16, v100
    v_and_b32 v117, 0xffff0000, v100
    v_lshlrev_b32 v118, 16, v101
    v_and_b32 v119, 0xffff0000, v101
    s_lshl_b32 s73, s3, 14
    s_add_u32 m0, s73, 73728
    s_lshl2_add_u32 s73, s62, s84
    s_add_u32 s73, s73, 2
    s_and_b32 s73, s73, 7
    s_lshl3_add_u32 s73, s63, s73
    s_lshl_b32 s73, s73, 8
    s_add_u32 s73, s73, s65
    s_lshl_b32 s73, s73, 7
    buffer_load_dwordx4 v19, s[20:23], s73 offen offset:0 lds
    v_lshlrev_b32 v120, 16, v102
    v_and_b32 v121, 0xffff0000, v102
    v_lshlrev_b32 v122, 16, v103
    v_and_b32 v123, 0xffff0000, v103
    v_lshlrev_b32 v124, 16, v104
    v_and_b32 v125, 0xffff0000, v104
    v_lshlrev_b32 v126, 16, v105
    v_and_b32 v127, 0xffff0000, v105
    v_lshlrev_b32 v128, 16, v106
    v_and_b32 v129, 0xffff0000, v106
    v_lshlrev_b32 v130, 16, v107
    v_and_b32 v131, 0xffff0000, v107
    v_pk_mul_f32 v[146:147], v[146:147], v[116:117] op_sel:[0,0] op_sel_hi:[1,1]
    v_pk_mul_f32 v[148:149], v[148:149], v[118:119] op_sel:[0,0] op_sel_hi:[1,1]
    v_pk_mul_f32 v[150:151], v[150:151], v[120:121] op_sel:[0,0] op_sel_hi:[1,1]
    v_pk_mul_f32 v[152:153], v[152:153], v[122:123] op_sel:[0,0] op_sel_hi:[1,1]
    buffer_load_dwordx4 v20, s[20:23], s73 offen offset:1024 lds
    v_pk_mul_f32 v[154:155], v[154:155], v[124:125] op_sel:[0,0] op_sel_hi:[1,1]
    v_pk_mul_f32 v[156:157], v[156:157], v[126:127] op_sel:[0,0] op_sel_hi:[1,1]
    v_pk_mul_f32 v[158:159], v[158:159], v[128:129] op_sel:[0,0] op_sel_hi:[1,1]
    v_pk_mul_f32 v[160:161], v[160:161], v[130:131] op_sel:[0,0] op_sel_hi:[1,1]
    v_cvt_pk_bf16_f32 v100, v160, v158
    v_cvt_pk_bf16_f32 v101, v156, v154
    v_cvt_pk_bf16_f32 v102, v152, v150
    v_cvt_pk_bf16_f32 v103, v148, v146
    v_cvt_pk_bf16_f32 v104, v161, v159
    v_cvt_pk_bf16_f32 v105, v157, v155
    v_cvt_pk_bf16_f32 v106, v153, v151
    v_cvt_pk_bf16_f32 v107, v149, v147
    s_movk_i32 s58, 4096
    buffer_store_dwordx4 v[100:103], v112, s[36:39], 0 offen sc1
    buffer_store_dwordx4 v[104:107], v112, s[36:39], s58 offen sc1
    s_lshl_b32 s59, s62, 15
    s_add_u32 s59, s59, 65536
    v_add_u32 v49, s59, v23
    v_add_u32 v50, s59, v24
    v_add_u32 v51, s59, v25
    v_add_u32 v108, s59, v26
    s_lshl_b32 s87, s64, 10
    s_add_u32 s87, s87, 0xf40000
    s_lshl1_add_u32 s58, s64, s63
    s_lshl_b32 s58, s58, 15
    s_lshl_b32 s59, s62, 13
    s_add_u32 s74, s58, s59
    s_lshl_b32 s75, s84, 10
    v_add_u32 v12, 16384, v11
    s_lshr_b32 s58, s65, 2
    s_lshl_b32 s58, s58, 8
    s_and_b32 s83, s65, 3
    s_lshl2_add_u32 s83, s83, s58
    s_add_u32 s83, s83, s87
    s_bitcmp1_b32 s65, 1
    s_cselect_b32 s58, -1, 1
    s_cselect_b32 s59, 64, 0
    s_add_u32 s58, s58, s64
    s_and_b32 s58, s58, 31
    s_and_b32 s60, s65, 1
    s_add_u32 s59, s59, s60
    s_lshr_b32 s60, s65, 2
    s_lshl1_add_u32 s59, s60, s59
    s_lshl_b32 s58, s58, 10
    s_lshl2_add_u32 s58, s59, s58
    s_add_u32 s58, s58, 0xf40200
    s_waitcnt vmcnt(8)
    s_barrier
    s_cmp_eq_u32 s3, 0
    s_cbranch_scc0 L_skip_6
    v_mov_b32 v1, s69
    v_mov_b32 v2, 0
    s_mov_b64 exec, 1
    buffer_store_dword v1, v2, s[36:39], s83 offen sc1
    buffer_store_dword v1, v2, s[36:39], s58 offen sc1
    s_mov_b64 exec, -1
L_skip_6:
    buffer_load_dwordx4 v21, s[20:23], s73 offen offset:2048 lds
    buffer_load_dwordx4 v22, s[20:23], s73 offen offset:3072 lds
    s_lshl_b32 s73, s3, 14
    s_add_u32 m0, s73, 77824
    s_lshl2_add_u32 s73, s62, s84
    s_add_u32 s73, s73, 3
    s_and_b32 s73, s73, 7
    s_lshl3_add_u32 s73, s63, s73
    s_lshl_b32 s73, s73, 8
    s_add_u32 s73, s73, s65
    s_lshl_b32 s73, s73, 7
    buffer_load_dwordx4 v19, s[20:23], s73 offen offset:0 lds
    buffer_load_dwordx4 v20, s[20:23], s73 offen offset:1024 lds
    buffer_load_dwordx4 v21, s[20:23], s73 offen offset:2048 lds
    buffer_load_dwordx4 v22, s[20:23], s73 offen offset:3072 lds
    s_lshl_b32 s59, s65, 5
    s_add_u32 s59, s59, s64
    s_lshr_b32 s58, s59, 2
    s_lshl_b32 s58, s58, 8
    s_and_b32 s83, s59, 3
    s_lshl2_add_u32 s83, s83, s58
    s_add_u32 s83, s83, 0xf50000
    s_waitcnt vmcnt(0)
    s_barrier
    s_cmp_eq_u32 s3, 0
    s_cbranch_scc0 L_skip_7
    v_mov_b32 v1, s69
    v_mov_b32 v2, 0
    s_mov_b64 exec, 1
    buffer_store_dword v1, v2, s[36:39], s83 offen sc1
    s_mov_b64 exec, -1
L_skip_7:
    s_cmp_eq_u32 s3, 0
    s_cbranch_scc0 L_skip_8
    v_and_b32 v1, 12, v0
    v_and_b32 v2, 3, v0
    v_lshlrev_b32 v1, 6, v1
    v_lshl_add_u32 v1, v2, 2, v1
    v_add_u32 v15, s87, v1
    s_mov_b32 s72, 32768
L_poll_9:
    buffer_load_dword v1, v15, s[36:39], 0 offen sc1
    s_sub_u32 s72, s72, 1
    s_cbranch_scc1 L_polled_10
    s_waitcnt vmcnt(0)
    v_cmp_ne_u32 vcc, s69, v1
    s_cbranch_vccnz L_poll_9
L_polled_10:
    s_waitcnt vmcnt(0)
L_skip_8:
    s_barrier
    s_add_u32 s76, s74, s75
    buffer_load_dwordx4 a[0:3], v11, s[36:39], s76 offen sc1
    buffer_load_dwordx4 a[4:7], v12, s[36:39], s76 offen sc1
    s_add_u32 s75, s75, 1024
    s_and_b32 s75, s75, 0x1fff
    s_add_u32 s76, s74, s75
    buffer_load_dwordx4 a[8:11], v11, s[36:39], s76 offen sc1
    buffer_load_dwordx4 a[12:15], v12, s[36:39], s76 offen sc1
    s_add_u32 s75, s75, 1024
    s_and_b32 s75, s75, 0x1fff
    s_add_u32 s76, s74, s75
    buffer_load_dwordx4 a[16:19], v11, s[36:39], s76 offen sc1
    buffer_load_dwordx4 a[20:23], v12, s[36:39], s76 offen sc1
    ds_read_b64_tr_b16 v[120:121], v49 offset:0
    ds_read_b64_tr_b16 v[122:123], v49 offset:2048
    ds_read_b64_tr_b16 v[124:125], v50 offset:0
    ds_read_b64_tr_b16 v[126:127], v50 offset:2048
    ds_read_b64_tr_b16 v[128:129], v51 offset:0
    ds_read_b64_tr_b16 v[130:131], v51 offset:2048
    ds_read_b64_tr_b16 v[132:133], v108 offset:0
    ds_read_b64_tr_b16 v[134:135], v108 offset:2048
    s_mul_i32 s58, s62, 4160
    s_add_u32 s58, s58, s82
    v_mov_b32 v152, 0
    v_mov_b32 v153, 0
    v_mov_b32 v154, 0
    v_mov_b32 v155, 0
    s_add_u32 s60, s82, 12384
    v_add_u32 v1, s60, v11
    s_mov_b64 exec, 0x3fffffff
    ds_write_b128 v1, v[152:155]
    s_lshl_b32 s61, s70, 16
    s_cmp_eq_u32 s62, 0
    s_cselect_b32 s61, s61, 0
    v_add_u32 v1, s58, v11
    s_mov_b64 exec, 2
    v_mov_b32 v155, s61
    s_mov_b64 exec, 3
    ds_write_b128 v1, v[152:155]
    s_mov_b64 exec, -1
    s_lshr_b32 s58, s2, 5
    s_lshl_b32 s58, s58, 11
    s_add_u32 s58, s58, 0xf50000
    v_and_b32 v1, 28, v0
    v_and_b32 v2, 3, v0
    v_lshlrev_b32 v1, 6, v1
    v_lshl_add_u32 v1, v2, 2, v1
    v_add_u32 v15, s58, v1
    v_and_b32 v1, 31, v3
    v_lshlrev_b32 v1, 2, v1
    v_lshrrev_b32 v2, 1, v5
    v_lshl_add_u32 v109, v2, 11, v1
    s_cmp_eq_u32 s62, 1
    s_cbranch_scc0 L_skip_11
    v_swap_b32 v202, v203
    v_swap_b32 v204, v205
L_skip_11:
    v_lshlrev_b32 v152, 16, v60
    v_and_b32 v153, 0xffff0000, v60
    v_lshlrev_b32 v154, 16, v61
    v_and_b32 v155, 0xffff0000, v61
    v_lshlrev_b32 v156, 16, v62
    v_and_b32 v157, 0xffff0000, v62
    v_lshlrev_b32 v158, 16, v63
    v_and_b32 v159, 0xffff0000, v63
    v_lshlrev_b32 v160, 16, v64
    v_and_b32 v161, 0xffff0000, v64
    v_lshlrev_b32 v162, 16, v65
    v_and_b32 v163, 0xffff0000, v65
    v_lshlrev_b32 v164, 16, v66
    v_and_b32 v165, 0xffff0000, v66
    v_lshlrev_b32 v166, 16, v67
    v_and_b32 v167, 0xffff0000, v67
    v_pk_add_f32 v[152:153], v[152:153], v[202:203] op_sel:[0,0] op_sel_hi:[1,0] neg_lo:[0,1] neg_hi:[0,1]
    v_pk_add_f32 v[154:155], v[154:155], v[202:203] op_sel:[0,0] op_sel_hi:[1,0] neg_lo:[0,1] neg_hi:[0,1]
    v_pk_add_f32 v[156:157], v[156:157], v[202:203] op_sel:[0,0] op_sel_hi:[1,0] neg_lo:[0,1] neg_hi:[0,1]
    v_pk_add_f32 v[158:159], v[158:159], v[202:203] op_sel:[0,0] op_sel_hi:[1,0] neg_lo:[0,1] neg_hi:[0,1]
    v_pk_add_f32 v[160:161], v[160:161], v[202:203] op_sel:[0,1] op_sel_hi:[1,1] neg_lo:[0,1] neg_hi:[0,1]
    v_pk_add_f32 v[162:163], v[162:163], v[202:203] op_sel:[0,1] op_sel_hi:[1,1] neg_lo:[0,1] neg_hi:[0,1]
    v_pk_add_f32 v[164:165], v[164:165], v[202:203] op_sel:[0,1] op_sel_hi:[1,1] neg_lo:[0,1] neg_hi:[0,1]
    v_pk_add_f32 v[166:167], v[166:167], v[202:203] op_sel:[0,1] op_sel_hi:[1,1] neg_lo:[0,1] neg_hi:[0,1]
    v_cvt_pk_bf16_f32 v68, v152, v153
    v_cvt_pk_bf16_f32 v69, v154, v155
    v_cvt_pk_bf16_f32 v70, v156, v157
    v_cvt_pk_bf16_f32 v71, v158, v159
    v_cvt_pk_bf16_f32 v72, v160, v161
    v_cvt_pk_bf16_f32 v73, v162, v163
    v_cvt_pk_bf16_f32 v74, v164, v165
    v_cvt_pk_bf16_f32 v75, v166, v167
    v_lshlrev_b32 v152, 16, v68
    v_and_b32 v153, 0xffff0000, v68
    v_lshlrev_b32 v154, 16, v69
    v_and_b32 v155, 0xffff0000, v69
    v_lshlrev_b32 v156, 16, v70
    v_and_b32 v157, 0xffff0000, v70
    v_lshlrev_b32 v158, 16, v71
    v_and_b32 v159, 0xffff0000, v71
    v_lshlrev_b32 v160, 16, v72
    v_and_b32 v161, 0xffff0000, v72
    v_lshlrev_b32 v162, 16, v73
    v_and_b32 v163, 0xffff0000, v73
    v_lshlrev_b32 v164, 16, v74
    v_and_b32 v165, 0xffff0000, v74
    v_lshlrev_b32 v166, 16, v75
    v_and_b32 v167, 0xffff0000, v75
    v_pk_mul_f32 v[152:153], v[152:153], v[204:205] op_sel:[0,0] op_sel_hi:[1,0]
    v_pk_mul_f32 v[154:155], v[154:155], v[204:205] op_sel:[0,0] op_sel_hi:[1,0]
    v_pk_mul_f32 v[156:157], v[156:157], v[204:205] op_sel:[0,0] op_sel_hi:[1,0]
    v_pk_mul_f32 v[158:159], v[158:159], v[204:205] op_sel:[0,0] op_sel_hi:[1,0]
    v_pk_mul_f32 v[160:161], v[160:161], v[204:205] op_sel:[0,1] op_sel_hi:[1,1]
    v_pk_mul_f32 v[162:163], v[162:163], v[204:205] op_sel:[0,1] op_sel_hi:[1,1]
    v_pk_mul_f32 v[164:165], v[164:165], v[204:205] op_sel:[0,1] op_sel_hi:[1,1]
    v_pk_mul_f32 v[166:167], v[166:167], v[204:205] op_sel:[0,1] op_sel_hi:[1,1]
    v_cvt_pk_bf16_f32 v68, v152, v153
    v_cvt_pk_bf16_f32 v69, v154, v155
    v_cvt_pk_bf16_f32 v70, v156, v157
    v_cvt_pk_bf16_f32 v71, v158, v159
    v_cvt_pk_bf16_f32 v72, v160, v161
    v_cvt_pk_bf16_f32 v73, v162, v163
    v_cvt_pk_bf16_f32 v74, v164, v165
    v_cvt_pk_bf16_f32 v75, v166, v167
    v_lshlrev_b32 v152, 16, v68
    v_and_b32 v153, 0xffff0000, v68
    v_lshlrev_b32 v154, 16, v69
    v_and_b32 v155, 0xffff0000, v69
    v_lshlrev_b32 v156, 16, v70
    v_and_b32 v157, 0xffff0000, v70
    v_lshlrev_b32 v158, 16, v71
    v_and_b32 v159, 0xffff0000, v71
    v_lshlrev_b32 v160, 16, v72
    v_and_b32 v161, 0xffff0000, v72
    v_lshlrev_b32 v162, 16, v73
    v_and_b32 v163, 0xffff0000, v73
    v_lshlrev_b32 v164, 16, v74
    v_and_b32 v165, 0xffff0000, v74
    v_lshlrev_b32 v166, 16, v75
    v_and_b32 v167, 0xffff0000, v75
    v_and_b32 v1, 1, v4
    v_add_u32 v2, v4, v1
    v_lshlrev_b32 v2, 1, v2
    v_mul_u32_u24 v1, 4160, v1
    v_lshl_add_u32 v2, v5, 4, v2
    s_lshl_b32 s60, s62, 8
    s_add_u32 s60, s60, s82
    v_add3_u32 v27, v1, v2, s60
    v_add_u32 v28, 1024, v27
    v_add_u32 v29, 2048, v27
    v_add_u32 v30, 3072, v27
    v_lshlrev_b32 v1, 5, v4
    v_lshlrev_b32 v2, 4, v5
    v_sub_u32 v2, v2, v1
    s_add_u32 s60, s60, 8768
    v_add_u32 v16, s60, v2
    v_lshl_add_u32 v1, v5, 3, v1
    s_lshl_b32 s60, s62, 11
    s_sub_u32 s60, s82, s60
    s_add_u32 s60, s60, 10840
    v_sub_u32 v17, s60, v1
    s_waitcnt vmcnt(4)
    s_waitcnt lgkmcnt(8)
    s_add_u32 s75, s75, 1024
    s_and_b32 s75, s75, 0x1fff
    s_add_u32 s76, s74, s75
    buffer_load_dwordx4 a[24:27], v11, s[36:39], s76 offen sc1
    v_mfma_f32_16x16x32_bf16 v[84:87], v[120:123], a[0:3], 0
    ds_read_b64_tr_b16 v[136:137], v49 offset:4096
    v_mfma_f32_16x16x32_bf16 v[100:103], v[120:123], a[4:7], 0
    ds_read_b64_tr_b16 v[138:139], v49 offset:6144
    s_waitcnt lgkmcnt(8)
    v_mfma_f32_16x16x32_bf16 v[88:91], v[124:127], a[0:3], 0
    buffer_load_dwordx4 a[28:31], v12, s[36:39], s76 offen sc1
    ds_read_b64_tr_b16 v[140:141], v50 offset:4096
    v_mfma_f32_16x16x32_bf16 v[104:107], v[124:127], a[4:7], 0
    ds_read_b64_tr_b16 v[142:143], v50 offset:6144
    s_waitcnt lgkmcnt(8)
    v_mfma_f32_16x16x32_bf16 v[92:95], v[128:131], a[0:3], 0
    ds_read_b64_tr_b16 v[144:145], v51 offset:4096
    v_mfma_f32_16x16x32_bf16 v[112:115], v[128:131], a[4:7], 0
    s_add_u32 s75, s75, 1024
    s_and_b32 s75, s75, 0x1fff
    s_add_u32 s76, s74, s75
    buffer_load_dwordx4 a[32:35], v11, s[36:39], s76 offen sc1
    ds_read_b64_tr_b16 v[146:147], v51 offset:6144
    s_waitcnt lgkmcnt(8)
    v_mfma_f32_16x16x32_bf16 v[96:99], v[132:135], a[0:3], 0
    ds_read_b64_tr_b16 v[148:149], v108 offset:4096
    v_mfma_f32_16x16x32_bf16 v[116:119], v[132:135], a[4:7], 0
    ds_read_b64_tr_b16 v[150:151], v108 offset:6144
    s_waitcnt vmcnt(5)
    s_waitcnt lgkmcnt(6)
    v_mfma_f32_16x16x32_bf16 v[84:87], v[136:139], a[8:11], v[84:87]
    buffer_load_dwordx4 a[36:39], v12, s[36:39], s76 offen sc1
    ds_read_b64_tr_b16 v[120:121], v49 offset:8192
    v_mfma_f32_16x16x32_bf16 v[100:103], v[136:139], a[12:15], v[100:103]
    ds_read_b64_tr_b16 v[122:123], v49 offset:10240
    s_waitcnt lgkmcnt(6)
    v_mfma_f32_16x16x32_bf16 v[88:91], v[140:143], a[8:11], v[88:91]
    ds_read_b64_tr_b16 v[124:125], v50 offset:8192
    v_mfma_f32_16x16x32_bf16 v[104:107], v[140:143], a[12:15], v[104:107]
    s_add_u32 s75, s75, 1024
    s_and_b32 s75, s75, 0x1fff
    s_add_u32 s76, s74, s75
    buffer_load_dwordx4 a[40:43], v11, s[36:39], s76 offen sc1
    ds_read_b64_tr_b16 v[126:127], v50 offset:10240
    s_waitcnt lgkmcnt(6)
    v_mfma_f32_16x16x32_bf16 v[92:95], v[144:147], a[8:11], v[92:95]
    ds_read_b64_tr_b16 v[128:129], v51 offset:8192
    v_mfma_f32_16x16x32_bf16 v[112:115], v[144:147], a[12:15], v[112:115]
    ds_read_b64_tr_b16 v[130:131], v51 offset:10240
    s_waitcnt lgkmcnt(6)
    v_mfma_f32_16x16x32_bf16 v[96:99], v[148:151], a[8:11], v[96:99]
    buffer_load_dwordx4 a[44:47], v12, s[36:39], s76 offen sc1
    ds_read_b64_tr_b16 v[132:133], v108 offset:8192
    v_mfma_f32_16x16x32_bf16 v[116:119], v[148:151], a[12:15], v[116:119]
    ds_read_b64_tr_b16 v[134:135], v108 offset:10240
    s_waitcnt vmcnt(6)
    s_waitcnt lgkmcnt(6)
    v_mfma_f32_16x16x32_bf16 v[84:87], v[120:123], a[16:19], v[84:87]
    ds_read_b64_tr_b16 v[136:137], v49 offset:12288
    v_mfma_f32_16x16x32_bf16 v[100:103], v[120:123], a[20:23], v[100:103]
    s_add_u32 s75, s75, 1024
    s_and_b32 s75, s75, 0x1fff
    s_add_u32 s76, s74, s75
    buffer_load_dwordx4 a[48:51], v11, s[36:39], s76 offen sc1
    ds_read_b64_tr_b16 v[138:139], v49 offset:14336
    s_waitcnt lgkmcnt(6)
    v_mfma_f32_16x16x32_bf16 v[88:91], v[124:127], a[16:19], v[88:91]
    ds_read_b64_tr_b16 v[140:141], v50 offset:12288
    v_mfma_f32_16x16x32_bf16 v[104:107], v[124:127], a[20:23], v[104:107]
    ds_read_b64_tr_b16 v[142:143], v50 offset:14336
    s_waitcnt lgkmcnt(6)
    v_mfma_f32_16x16x32_bf16 v[92:95], v[128:131], a[16:19], v[92:95]
    buffer_load_dwordx4 a[52:55], v12, s[36:39], s76 offen sc1
    ds_read_b64_tr_b16 v[144:145], v51 offset:12288
    v_mfma_f32_16x16x32_bf16 v[112:115], v[128:131], a[20:23], v[112:115]
    ds_read_b64_tr_b16 v[146:147], v51 offset:14336
    s_waitcnt lgkmcnt(6)
    v_mfma_f32_16x16x32_bf16 v[96:99], v[132:135], a[16:19], v[96:99]
    ds_read_b64_tr_b16 v[148:149], v108 offset:12288
    v_mfma_f32_16x16x32_bf16 v[116:119], v[132:135], a[20:23], v[116:119]
    s_add_u32 s75, s75, 1024
    s_and_b32 s75, s75, 0x1fff
    s_add_u32 s76, s74, s75
    buffer_load_dwordx4 a[56:59], v11, s[36:39], s76 offen sc1
    ds_read_b64_tr_b16 v[150:151], v108 offset:14336
    s_waitcnt vmcnt(7)
    s_waitcnt lgkmcnt(6)
    v_mfma_f32_16x16x32_bf16 v[84:87], v[136:139], a[24:27], v[84:87]
    ds_read_b64_tr_b16 v[120:121], v49 offset:16384
    v_mfma_f32_16x16x32_bf16 v[100:103], v[136:139], a[28:31], v[100:103]
    ds_read_b64_tr_b16 v[122:123], v49 offset:18432
    s_waitcnt lgkmcnt(6)
    v_mfma_f32_16x16x32_bf16 v[88:91], v[140:143], a[24:27], v[88:91]
    buffer_load_dwordx4 a[60:63], v12, s[36:39], s76 offen sc1
    ds_read_b64_tr_b16 v[124:125], v50 offset:16384
    v_mfma_f32_16x16x32_bf16 v[104:107], v[140:143], a[28:31], v[104:107]
    ds_read_b64_tr_b16 v[126:127], v50 offset:18432
    s_waitcnt lgkmcnt(6)
    v_mfma_f32_16x16x32_bf16 v[92:95], v[144:147], a[24:27], v[92:95]
    ds_read_b64_tr_b16 v[128:129], v51 offset:16384
    v_mfma_f32_16x16x32_bf16 v[112:115], v[144:147], a[28:31], v[112:115]
    buffer_load_dword v18, v15, s[36:39], 0 offen sc1
    ds_read_b64_tr_b16 v[130:131], v51 offset:18432
    s_waitcnt lgkmcnt(6)
    v_mfma_f32_16x16x32_bf16 v[96:99], v[148:151], a[24:27], v[96:99]
    s_add_u32 m0, s78, 0
    s_add_u32 s73, s3, s85
    s_add_u32 s73, s73, 0
    s_and_b32 s73, s73, 15
    s_mul_i32 s73, s73, 114688
    s_add_u32 s73, s73, s79
    buffer_load_dwordx4 v31, s[24:27], s73 offen offset:0 lds
    ds_read_b64_tr_b16 v[132:133], v108 offset:16384
    v_mfma_f32_16x16x32_bf16 v[116:119], v[148:151], a[28:31], v[116:119]
    ds_read_b64_tr_b16 v[134:135], v108 offset:18432
    s_waitcnt vmcnt(8)
    s_waitcnt lgkmcnt(6)
    v_mfma_f32_16x16x32_bf16 v[84:87], v[120:123], a[32:35], v[84:87]
    ds_read_b64_tr_b16 v[136:137], v49 offset:20480
    v_mfma_f32_16x16x32_bf16 v[100:103], v[120:123], a[36:39], v[100:103]
    buffer_load_dwordx4 v32, s[24:27], s73 offen offset:1024 lds
    ds_read_b64_tr_b16 v[138:139], v49 offset:22528
    s_waitcnt lgkmcnt(6)
    v_mfma_f32_16x16x32_bf16 v[88:91], v[124:127], a[32:35], v[88:91]
    ds_read_b64_tr_b16 v[140:141], v50 offset:20480
    v_mfma_f32_16x16x32_bf16 v[104:107], v[124:127], a[36:39], v[104:107]
    ds_read_b64_tr_b16 v[142:143], v50 offset:22528
    s_waitcnt lgkmcnt(6)
    v_mfma_f32_16x16x32_bf16 v[92:95], v[128:131], a[32:35], v[92:95]
    buffer_load_dwordx4 v33, s[24:27], s73 offen offset:2048 lds
    ds_read_b64_tr_b16 v[144:145], v51 offset:20480
    v_mfma_f32_16x16x32_bf16 v[112:115], v[128:131], a[36:39], v[112:115]
    ds_read_b64_tr_b16 v[146:147], v51 offset:22528
    s_waitcnt lgkmcnt(6)
    v_mfma_f32_16x16x32_bf16 v[96:99], v[132:135], a[32:35], v[96:99]
    ds_read_b64_tr_b16 v[148:149], v108 offset:20480
    v_mfma_f32_16x16x32_bf16 v[116:119], v[132:135], a[36:39], v[116:119]
    buffer_load_dwordx4 v34, s[24:27], s73 offen offset:3072 lds
    ds_read_b64_tr_b16 v[150:151], v108 offset:22528
    s_waitcnt vmcnt(9)
    s_waitcnt lgkmcnt(6)
    v_mfma_f32_16x16x32_bf16 v[84:87], v[136:139], a[40:43], v[84:87]
    ds_read_b64_tr_b16 v[120:121], v49 offset:24576
    v_mfma_f32_16x16x32_bf16 v[100:103], v[136:139], a[44:47], v[100:103]
    ds_read_b64_tr_b16 v[122:123], v49 offset:26624
    s_waitcnt lgkmcnt(6)
    v_mfma_f32_16x16x32_bf16 v[88:91], v[140:143], a[40:43], v[88:91]
    s_add_u32 m0, s78, 4096
    s_nop 0
    buffer_load_dwordx4 v35, s[24:27], s73 offen offset:0 lds
    ds_read_b64_tr_b16 v[124:125], v50 offset:24576
    v_mfma_f32_16x16x32_bf16 v[104:107], v[140:143], a[44:47], v[104:107]
    ds_read_b64_tr_b16 v[126:127], v50 offset:26624
    s_waitcnt lgkmcnt(6)
    v_mfma_f32_16x16x32_bf16 v[92:95], v[144:147], a[40:43], v[92:95]
    ds_read_b64_tr_b16 v[128:129], v51 offset:24576
    v_mfma_f32_16x16x32_bf16 v[112:115], v[144:147], a[44:47], v[112:115]
    buffer_load_dwordx4 v36, s[24:27], s73 offen offset:1024 lds
    ds_read_b64_tr_b16 v[130:131], v51 offset:26624
    s_waitcnt lgkmcnt(6)
    v_mfma_f32_16x16x32_bf16 v[96:99], v[148:151], a[40:43], v[96:99]
    ds_read_b64_tr_b16 v[132:133], v108 offset:24576
    v_mfma_f32_16x16x32_bf16 v[116:119], v[148:151], a[44:47], v[116:119]
    ds_read_b64_tr_b16 v[134:135], v108 offset:26624
    s_waitcnt vmcnt(9)
    s_waitcnt lgkmcnt(6)
    v_mfma_f32_16x16x32_bf16 v[84:87], v[120:123], a[48:51], v[84:87]
    buffer_load_dwordx4 v37, s[24:27], s73 offen offset:2048 lds
    ds_read_b64_tr_b16 v[136:137], v49 offset:28672
    v_mfma_f32_16x16x32_bf16 v[100:103], v[120:123], a[52:55], v[100:103]
    ds_read_b64_tr_b16 v[138:139], v49 offset:30720
    s_waitcnt lgkmcnt(6)
    v_mfma_f32_16x16x32_bf16 v[88:91], v[124:127], a[48:51], v[88:91]
    ds_read_b64_tr_b16 v[140:141], v50 offset:28672
    v_mfma_f32_16x16x32_bf16 v[104:107], v[124:127], a[52:55], v[104:107]
    s_lshl_b32 s73, s62, 10
    s_add_u32 s73, s73, s82
    s_add_u32 m0, s73, 4192
    s_lshl1_add_u32 s73, s2, s63
    s_lshl2_add_u32 s73, s73, s62
    s_lshl_b32 s73, s73, 10
    buffer_load_dwordx4 v11, s[32:35], s73 offen offset:0 nt lds
    ds_read_b64_tr_b16 v[142:143], v50 offset:30720
    s_waitcnt lgkmcnt(6)
    v_mfma_f32_16x16x32_bf16 v[92:95], v[128:131], a[48:51], v[92:95]
    ds_read_b64_tr_b16 v[144:145], v51 offset:28672
    v_mfma_f32_16x16x32_bf16 v[112:115], v[128:131], a[52:55], v[112:115]
    ds_read_b64_tr_b16 v[146:147], v51 offset:30720
    s_waitcnt lgkmcnt(6)
    v_mfma_f32_16x16x32_bf16 v[96:99], v[132:135], a[48:51], v[96:99]
    buffer_load_dwordx4 v11, s[32:35], s73 offen offset:1024 nt lds
    ds_read_b64_tr_b16 v[148:149], v108 offset:28672
    v_mfma_f32_16x16x32_bf16 v[116:119], v[132:135], a[52:55], v[116:119]
    ds_read_b64_tr_b16 v[150:151], v108 offset:30720
    s_waitcnt vmcnt(10)
    s_waitcnt lgkmcnt(6)
    v_mfma_f32_16x16x32_bf16 v[84:87], v[136:139], a[56:59], v[84:87]
    v_mfma_f32_16x16x32_bf16 v[100:103], v[136:139], a[60:63], v[100:103]
    s_waitcnt lgkmcnt(4)
    buffer_load_dwordx4 v11, s[32:35], s73 offen offset:2048 nt lds
    v_mfma_f32_16x16x32_bf16 v[88:91], v[140:143], a[56:59], v[88:91]
    v_mfma_f32_16x16x32_bf16 v[104:107], v[140:143], a[60:63], v[104:107]
    s_waitcnt lgkmcnt(2)
    v_mfma_f32_16x16x32_bf16 v[92:95], v[144:147], a[56:59], v[92:95]
    v_mfma_f32_16x16x32_bf16 v[112:115], v[144:147], a[60:63], v[112:115]
    s_waitcnt lgkmcnt(0)
    v_mfma_f32_16x16x32_bf16 v[96:99], v[148:151], a[56:59], v[96:99]
    v_mfma_f32_16x16x32_bf16 v[116:119], v[148:151], a[60:63], v[116:119]
    s_barrier
    s_nop 2
    ds_write_b128 v13, v[92:95] offset:28672
    s_nop 1
    ds_write_b128 v13, v[96:99] offset:29696
    ds_write_b128 v13, v[112:115] offset:30720
    ds_write_b128 v13, v[116:119] offset:31744
    s_lshl1_add_u32 s58, s64, s63
    s_lshl_b32 s58, s58, 5
    s_lshl1_add_u32 s59, s65, s62
    s_add_u32 s58, s58, s59
    s_lshl_b32 s59, s58, 10
    s_add_u32 s59, s59, 0x200000
    s_add_u32 s60, s59, 16384
    s_lshl_b32 s58, s58, 7
    s_add_u32 s58, s58, 0xf00000
    s_waitcnt lgkmcnt(0)
    s_barrier
    ds_read_b128 v[92:95], v14 offset:28672
    ds_read_b128 v[96:99], v14 offset:29696
    ds_read_b128 v[112:115], v14 offset:30720
    ds_read_b128 v[116:119], v14 offset:31744
    v_pk_add_f32 v[168:169], v[84:85], v[152:153] op_sel:[0,0] op_sel_hi:[1,1]
    v_pk_add_f32 v[170:171], v[86:87], v[154:155] op_sel:[0,0] op_sel_hi:[1,1]
    v_pk_add_f32 v[172:173], v[88:89], v[156:157] op_sel:[0,0] op_sel_hi:[1,1]
    v_pk_add_f32 v[174:175], v[90:91], v[158:159] op_sel:[0,0] op_sel_hi:[1,1]
    v_pk_add_f32 v[176:177], v[100:101], v[160:161] op_sel:[0,0] op_sel_hi:[1,1]
    v_pk_add_f32 v[178:179], v[102:103], v[162:163] op_sel:[0,0] op_sel_hi:[1,1]
    v_pk_add_f32 v[180:181], v[104:105], v[164:165] op_sel:[0,0] op_sel_hi:[1,1]
    v_pk_add_f32 v[182:183], v[106:107], v[166:167] op_sel:[0,0] op_sel_hi:[1,1]
    s_waitcnt lgkmcnt(2)
    v_pk_add_f32 v[168:169], v[168:169], v[92:93] op_sel:[0,0] op_sel_hi:[1,1]
    v_pk_add_f32 v[170:171], v[170:171], v[94:95] op_sel:[0,0] op_sel_hi:[1,1]
    v_pk_add_f32 v[172:173], v[172:173], v[96:97] op_sel:[0,0] op_sel_hi:[1,1]
    v_pk_add_f32 v[174:175], v[174:175], v[98:99] op_sel:[0,0] op_sel_hi:[1,1]
    v_cvt_pk_bf16_f32 v76, v168, v169
    v_cvt_pk_bf16_f32 v77, v170, v171
    v_cvt_pk_bf16_f32 v78, v172, v173
    v_cvt_pk_bf16_f32 v79, v174, v175
    buffer_store_dwordx4 v[76:79], v11, s[36:39], s59 offen sc1
    s_waitcnt lgkmcnt(0)
    v_pk_add_f32 v[176:177], v[176:177], v[112:113] op_sel:[0,0] op_sel_hi:[1,1]
    v_pk_add_f32 v[178:179], v[178:179], v[114:115] op_sel:[0,0] op_sel_hi:[1,1]
    v_pk_add_f32 v[180:181], v[180:181], v[116:117] op_sel:[0,0] op_sel_hi:[1,1]
    v_pk_add_f32 v[182:183], v[182:183], v[118:119] op_sel:[0,0] op_sel_hi:[1,1]
    v_cvt_pk_bf16_f32 v80, v176, v177
    v_cvt_pk_bf16_f32 v81, v178, v179
    v_cvt_pk_bf16_f32 v82, v180, v181
    v_cvt_pk_bf16_f32 v83, v182, v183
    buffer_store_dwordx4 v[80:83], v11, s[36:39], s60 offen sc1
    v_lshlrev_b32 v168, 16, v76
    v_and_b32 v169, 0xffff0000, v76
    v_lshlrev_b32 v170, 16, v77
    v_and_b32 v171, 0xffff0000, v77
    v_lshlrev_b32 v172, 16, v78
    v_and_b32 v173, 0xffff0000, v78
    v_lshlrev_b32 v174, 16, v79
    v_and_b32 v175, 0xffff0000, v79
    v_lshlrev_b32 v176, 16, v80
    v_and_b32 v177, 0xffff0000, v80
    v_lshlrev_b32 v178, 16, v81
    v_and_b32 v179, 0xffff0000, v81
    v_lshlrev_b32 v180, 16, v82
    v_and_b32 v181, 0xffff0000, v82
    v_lshlrev_b32 v182, 16, v83
    v_and_b32 v183, 0xffff0000, v83
    v_pk_add_f32 v[184:185], v[168:169], v[170:171] op_sel:[0,0] op_sel_hi:[1,1]
    v_pk_mul_f32 v[186:187], v[168:169], v[168:169] op_sel:[0,0] op_sel_hi:[1,1]
    v_pk_add_f32 v[188:189], v[176:177], v[178:179] op_sel:[0,0] op_sel_hi:[1,1]
    v_pk_mul_f32 v[190:191], v[176:177], v[176:177] op_sel:[0,0] op_sel_hi:[1,1]
    v_pk_fma_f32 v[186:187], v[170:171], v[170:171], v[186:187] op_sel:[0,0,0] op_sel_hi:[1,1,1]
    v_pk_fma_f32 v[190:191], v[178:179], v[178:179], v[190:191] op_sel:[0,0,0] op_sel_hi:[1,1,1]
    v_pk_add_f32 v[184:185], v[184:185], v[172:173] op_sel:[0,0] op_sel_hi:[1,1]
    v_pk_fma_f32 v[186:187], v[172:173], v[172:173], v[186:187] op_sel:[0,0,0] op_sel_hi:[1,1,1]
    v_pk_add_f32 v[188:189], v[188:189], v[180:181] op_sel:[0,0] op_sel_hi:[1,1]
    v_pk_fma_f32 v[190:191], v[180:181], v[180:181], v[190:191] op_sel:[0,0,0] op_sel_hi:[1,1,1]
    v_pk_add_f32 v[184:185], v[184:185], v[174:175] op_sel:[0,0] op_sel_hi:[1,1]
    v_pk_fma_f32 v[186:187], v[174:175], v[174:175], v[186:187] op_sel:[0,0,0] op_sel_hi:[1,1,1]
    v_pk_add_f32 v[188:189], v[188:189], v[182:183] op_sel:[0,0] op_sel_hi:[1,1]
    v_pk_fma_f32 v[190:191], v[182:183], v[182:183], v[190:191] op_sel:[0,0,0] op_sel_hi:[1,1,1]
    v_add_f32 v184, v184, v185
    v_add_f32 v186, v186, v187
    v_add_f32 v188, v188, v189
    v_add_f32 v190, v190, v191
    s_nop 0
    v_permlane32_swap_b32 v184, v188
    v_permlane32_swap_b32 v186, v190
    v_add_f32 v184, v184, v188
    v_add_f32 v186, v186, v190
    s_nop 1
    v_permlane16_swap_b32 v184, v186
    v_add_f32 v184, v184, v186
    buffer_store_dword v184, v109, s[36:39], s58 offen sc1
    s_lshl3_add_u32 s59, s64, s65
    s_lshr_b32 s58, s59, 2
    s_lshl_b32 s58, s58, 8
    s_and_b32 s83, s59, 3
    s_lshl2_add_u32 s83, s83, s58
    s_add_u32 s83, s83, 0xf48000
    s_lshl_b32 s60, s66, 10
    s_add_u32 s87, s60, 0xf48000
    s_waitcnt vmcnt(13)
    v_cmp_ne_u32 vcc, s69, v18
    s_cbranch_vccz L_kvok_12
    s_mov_b32 s72, 32768
L_poll_13:
    buffer_load_dword v1, v15, s[36:39], 0 offen sc1
    s_sub_u32 s72, s72, 1
    s_cbranch_scc1 L_polled_14
    s_waitcnt vmcnt(0)
    v_cmp_ne_u32 vcc, s69, v1
    s_cbranch_vccnz L_poll_13
L_polled_14:
    s_waitcnt vmcnt(0)
L_kvok_12:
    s_lshl_b32 s73, s62, 11
    s_add_u32 s73, s73, s82
    s_add_u32 m0, s73, 8288
    s_lshl1_add_u32 s73, s2, s63
    s_lshl1_add_u32 s73, s73, s62
    s_lshl_b32 s73, s73, 11
    s_add_u32 s73, s73, 0x400000
    buffer_load_dwordx4 v11, s[36:39], s73 offen sc1 lds
    buffer_load_dwordx4 v11, s[36:39], s73 offen offset:1024 sc1 lds
    s_lshl_b32 s60, s62, 11
    s_add_u32 s60, s60, s82
    v_add_u32 v1, s60, v11
    s_waitcnt vmcnt(5)
    ds_read_b128 v[148:151], v1 offset:4192
    ds_read_b32 v152, v1 offset:4208
    ds_read_b128 v[156:159], v1 offset:5216
    ds_read_b32 v160, v1 offset:5232
    s_waitcnt lgkmcnt(0)
    v_alignbit_b32 v148, v149, v148, 16
    v_alignbit_b32 v149, v150, v149, 16
    v_alignbit_b32 v150, v151, v150, 16
    v_alignbit_b32 v151, v152, v151, 16
    ds_write_b128 v1, v[148:151] offset:32
    v_alignbit_b32 v156, v157, v156, 16
    v_alignbit_b32 v157, v158, v157, 16
    v_alignbit_b32 v158, v159, v158, 16
    v_alignbit_b32 v159, v160, v159, 16
    ds_write_b128 v1, v[156:159] offset:1056
    s_waitcnt vmcnt(0) lgkmcnt(0)
    s_barrier
    ds_read_b128 v[116:119], v16 offset:3584
    ds_read_b128 v[120:123], v16 offset:3072
    ds_read_b128 v[124:127], v16 offset:2560
    ds_read_b128 v[128:131], v16 offset:2048
    ds_read_b128 v[132:135], v16 offset:1536
    ds_read_b128 v[136:139], v16 offset:1024
    ds_read_b128 v[140:143], v16 offset:512
    ds_read_b128 v[144:147], v16 offset:0
    s_add_u32 m0, s78, 28672
    s_add_u32 s73, s3, s85
    s_add_u32 s73, s73, 4
    s_and_b32 s73, s73, 15
    s_mul_i32 s73, s73, 114688
    s_add_u32 s73, s73, s79
    buffer_load_dwordx4 v31, s[24:27], s73 offen offset:0 lds
    ds_read2_b32 v[84:85], v27 offset0:0 offset1:1
    ds_read2_b32 v[86:87], v27 offset0:2 offset1:3
    ds_read2_b32 v[88:89], v27 offset0:128 offset1:129
    ds_read2_b32 v[90:91], v27 offset0:130 offset1:131
    ds_read2_b32 v[92:93], v28 offset0:0 offset1:1
    ds_read2_b32 v[94:95], v28 offset0:2 offset1:3
    ds_read2_b32 v[96:97], v28 offset0:128 offset1:129
    ds_read2_b32 v[98:99], v28 offset0:130 offset1:131
    ds_read2_b32 v[100:101], v29 offset0:0 offset1:1
    ds_read2_b32 v[102:103], v29 offset0:2 offset1:3
    ds_read2_b32 v[104:105], v29 offset0:128 offset1:129
    ds_read2_b32 v[106:107], v29 offset0:130 offset1:131
    ds_read2_b32 v[108:109], v30 offset0:0 offset1:1
    ds_read2_b32 v[110:111], v30 offset0:2 offset1:3
    ds_read2_b32 v[112:113], v30 offset0:128 offset1:129
    ds_read2_b32 v[114:115], v30 offset0:130 offset1:131
    s_waitcnt lgkmcnt(14)
    buffer_load_dwordx4 v32, s[24:27], s73 offen offset:1024 lds
    v_mfma_f32_16x16x32_bf16 a[192:195], v[84:87], v[116:119], 0
    ds_read_b128 v[192:195], v16 offset:3648
    v_mfma_f32_16x16x32_bf16 a[196:199], v[84:87], v[120:123], 0
    ds_read_b128 v[196:199], v16 offset:3136
    v_mfma_f32_16x16x32_bf16 a[200:203], v[84:87], v[124:127], 0
    ds_read_b128 v[200:203], v16 offset:2624
    v_mfma_f32_16x16x32_bf16 a[204:207], v[84:87], v[128:131], 0
    buffer_load_dwordx4 v33, s[24:27], s73 offen offset:2048 lds
    ds_read_b128 v[204:207], v16 offset:2112
    v_mfma_f32_16x16x32_bf16 a[208:211], v[84:87], v[132:135], 0
    v_mfma_f32_16x16x32_bf16 a[212:215], v[84:87], v[136:139], 0
    ds_read_b128 v[208:211], v16 offset:1600
    v_mfma_f32_16x16x32_bf16 a[216:219], v[84:87], v[140:143], 0
    ds_read_b128 v[212:215], v16 offset:1088
    v_mfma_f32_16x16x32_bf16 a[220:223], v[84:87], v[144:147], 0
    buffer_load_dwordx4 v34, s[24:27], s73 offen offset:3072 lds
    ds_read_b128 v[216:219], v16 offset:576
    s_waitcnt lgkmcnt(15)
    v_mfma_f32_16x16x32_bf16 a[196:199], v[88:91], v[116:119], a[196:199]
    ds_read_b128 v[220:223], v16 offset:64
    v_mfma_f32_16x16x32_bf16 a[200:203], v[88:91], v[120:123], a[200:203]
    v_mfma_f32_16x16x32_bf16 a[204:207], v[88:91], v[124:127], a[204:207]
    ds_read2_b32 v[148:149], v27 offset0:16 offset1:17
    v_mfma_f32_16x16x32_bf16 a[208:211], v[88:91], v[128:131], a[208:211]
    s_add_u32 m0, s78, 32768
    s_nop 0
    buffer_load_dwordx4 v35, s[24:27], s73 offen offset:0 lds
    ds_read2_b32 v[150:151], v27 offset0:18 offset1:19
    v_mfma_f32_16x16x32_bf16 a[212:215], v[88:91], v[132:135], a[212:215]
    ds_read2_b32 v[152:153], v27 offset0:144 offset1:145
    v_mfma_f32_16x16x32_bf16 a[216:219], v[88:91], v[136:139], a[216:219]
    ds_read2_b32 v[154:155], v27 offset0:146 offset1:147
    v_mfma_f32_16x16x32_bf16 a[220:223], v[88:91], v[140:143], a[220:223]
    s_waitcnt lgkmcnt(15)
    v_mfma_f32_16x16x32_bf16 a[200:203], v[92:95], v[116:119], a[200:203]
    buffer_load_dwordx4 v36, s[24:27], s73 offen offset:1024 lds
    ds_read2_b32 v[156:157], v28 offset0:16 offset1:17
    v_mfma_f32_16x16x32_bf16 a[204:207], v[92:95], v[120:123], a[204:207]
    ds_read2_b32 v[158:159], v28 offset0:18 offset1:19
    v_mfma_f32_16x16x32_bf16 a[208:211], v[92:95], v[124:127], a[208:211]
    ds_read2_b32 v[160:161], v28 offset0:144 offset1:145
    v_mfma_f32_16x16x32_bf16 a[212:215], v[92:95], v[128:131], a[212:215]
    ds_read2_b32 v[162:163], v28 offset0:146 offset1:147
    v_mfma_f32_16x16x32_bf16 a[216:219], v[92:95], v[132:135], a[216:219]
    buffer_load_dwordx4 v37, s[24:27], s73 offen offset:2048 lds
    v_mfma_f32_16x16x32_bf16 a[220:223], v[92:95], v[136:139], a[220:223]
    ds_read2_b32 v[164:165], v29 offset0:16 offset1:17
    s_waitcnt lgkmcnt(15)
    v_mfma_f32_16x16x32_bf16 a[204:207], v[96:99], v[116:119], a[204:207]
    ds_read2_b32 v[166:167], v29 offset0:18 offset1:19
    v_mfma_f32_16x16x32_bf16 a[208:211], v[96:99], v[120:123], a[208:211]
    ds_read2_b32 v[168:169], v29 offset0:144 offset1:145
    v_mfma_f32_16x16x32_bf16 a[212:215], v[96:99], v[124:127], a[212:215]
    ds_read2_b32 v[170:171], v29 offset0:146 offset1:147
    v_mfma_f32_16x16x32_bf16 a[216:219], v[96:99], v[128:131], a[216:219]
    v_mfma_f32_16x16x32_bf16 a[220:223], v[96:99], v[132:135], a[220:223]
    ds_read2_b32 v[172:173], v30 offset0:16 offset1:17
    s_waitcnt lgkmcnt(15)
    v_mfma_f32_16x16x32_bf16 a[208:211], v[100:103], v[116:119], a[208:211]
    ds_read2_b32 v[174:175], v30 offset0:18 offset1:19
    v_mfma_f32_16x16x32_bf16 a[212:215], v[100:103], v[120:123], a[212:215]
    ds_read2_b32 v[176:177], v30 offset0:144 offset1:145
    v_mfma_f32_16x16x32_bf16 a[216:219], v[100:103], v[124:127], a[216:219]
    ds_read2_b32 v[178:179], v30 offset0:146 offset1:147
    v_mfma_f32_16x16x32_bf16 a[220:223], v[100:103], v[128:131], a[220:223]
    s_waitcnt lgkmcnt(15)
    v_mfma_f32_16x16x32_bf16 a[212:215], v[104:107], v[116:119], a[212:215]
    v_mfma_f32_16x16x32_bf16 a[216:219], v[104:107], v[120:123], a[216:219]
    v_mfma_f32_16x16x32_bf16 a[220:223], v[104:107], v[124:127], a[220:223]
    s_waitcnt lgkmcnt(15)
    v_mfma_f32_16x16x32_bf16 a[216:219], v[108:111], v[116:119], a[216:219]
    v_mfma_f32_16x16x32_bf16 a[220:223], v[108:111], v[120:123], a[220:223]
    s_waitcnt lgkmcnt(15)
    v_mfma_f32_16x16x32_bf16 a[220:223], v[112:115], v[116:119], a[220:223]
    s_barrier
    s_cmp_eq_u32 s3, 0
    s_cbranch_scc0 L_skip_15
    v_mov_b32 v1, s69
    v_mov_b32 v2, 0
    s_mov_b64 exec, 1
    buffer_store_dword v1, v2, s[36:39], s83 offen sc1
    s_mov_b64 exec, -1
L_skip_15:
    s_waitcnt lgkmcnt(14)
    v_mfma_f32_16x16x32_bf16 a[192:195], v[148:151], v[192:195], a[192:195]
    s_add_u32 m0, s78, 57344
    s_add_u32 s73, s3, s85
    s_add_u32 s73, s73, 8
    s_and_b32 s73, s73, 15
    s_mul_i32 s73, s73, 114688
    s_add_u32 s73, s73, s79
    buffer_load_dwordx4 v31, s[24:27], s73 offen offset:0 lds
    ds_read_b128 v[116:119], v16 offset:3712
    v_mfma_f32_16x16x32_bf16 a[196:199], v[148:151], v[196:199], a[196:199]
    ds_read_b128 v[120:123], v16 offset:3200
    v_mfma_f32_16x16x32_bf16 a[200:203], v[148:151], v[200:203], a[200:203]
    ds_read_b128 v[124:127], v16 offset:2688
    v_mfma_f32_16x16x32_bf16 a[204:207], v[148:151], v[204:207], a[204:207]
    ds_read_b128 v[128:131], v16 offset:2176
    v_mfma_f32_16x16x32_bf16 a[208:211], v[148:151], v[208:211], a[208:211]
    buffer_load_dwordx4 v32, s[24:27], s73 offen offset:1024 lds
    v_mfma_f32_16x16x32_bf16 a[212:215], v[148:151], v[212:215], a[212:215]
    ds_read_b128 v[132:135], v16 offset:1664
    v_mfma_f32_16x16x32_bf16 a[216:219], v[148:151], v[216:219], a[216:219]
    ds_read_b128 v[136:139], v16 offset:1152
    v_mfma_f32_16x16x32_bf16 a[220:223], v[148:151], v[220:223], a[220:223]
    ds_read_b128 v[140:143], v16 offset:640
    s_waitcnt lgkmcnt(15)
    v_mfma_f32_16x16x32_bf16 a[196:199], v[152:155], v[192:195], a[196:199]
    buffer_load_dwordx4 v33, s[24:27], s73 offen offset:2048 lds
    ds_read_b128 v[144:147], v16 offset:128
    v_mfma_f32_16x16x32_bf16 a[200:203], v[152:155], v[196:199], a[200:203]
    v_mfma_f32_16x16x32_bf16 a[204:207], v[152:155], v[200:203], a[204:207]
    ds_read2_b32 v[84:85], v27 offset0:32 offset1:33
    v_mfma_f32_16x16x32_bf16 a[208:211], v[152:155], v[204:207], a[208:211]
    ds_read2_b32 v[86:87], v27 offset0:34 offset1:35
    v_mfma_f32_16x16x32_bf16 a[212:215], v[152:155], v[208:211], a[212:215]
    buffer_load_dwordx4 v34, s[24:27], s73 offen offset:3072 lds
    ds_read2_b32 v[88:89], v27 offset0:160 offset1:161
    v_mfma_f32_16x16x32_bf16 a[216:219], v[152:155], v[212:215], a[216:219]
    ds_read2_b32 v[90:91], v27 offset0:162 offset1:163
    v_mfma_f32_16x16x32_bf16 a[220:223], v[152:155], v[216:219], a[220:223]
    s_waitcnt lgkmcnt(15)
    v_mfma_f32_16x16x32_bf16 a[200:203], v[156:159], v[192:195], a[200:203]
    ds_read2_b32 v[92:93], v28 offset0:32 offset1:33
    v_mfma_f32_16x16x32_bf16 a[204:207], v[156:159], v[196:199], a[204:207]
    s_add_u32 m0, s78, 61440
    s_nop 0
    buffer_load_dwordx4 v35, s[24:27], s73 offen offset:0 lds
    ds_read2_b32 v[94:95], v28 offset0:34 offset1:35
    v_mfma_f32_16x16x32_bf16 a[208:211], v[156:159], v[200:203], a[208:211]
    ds_read2_b32 v[96:97], v28 offset0:160 offset1:161
    v_mfma_f32_16x16x32_bf16 a[212:215], v[156:159], v[204:207], a[212:215]
    ds_read2_b32 v[98:99], v28 offset0:162 offset1:163
    v_mfma_f32_16x16x32_bf16 a[216:219], v[156:159], v[208:211], a[216:219]
    v_mfma_f32_16x16x32_bf16 a[220:223], v[156:159], v[212:215], a[220:223]
    buffer_load_dwordx4 v36, s[24:27], s73 offen offset:1024 lds
    ds_read2_b32 v[100:101], v29 offset0:32 offset1:33
    s_waitcnt lgkmcnt(15)
    v_mfma_f32_16x16x32_bf16 a[204:207], v[160:163], v[192:195], a[204:207]
    ds_read2_b32 v[102:103], v29 offset0:34 offset1:35
    v_mfma_f32_16x16x32_bf16 a[208:211], v[160:163], v[196:199], a[208:211]
    ds_read2_b32 v[104:105], v29 offset0:160 offset1:161
    v_mfma_f32_16x16x32_bf16 a[212:215], v[160:163], v[200:203], a[212:215]
    ds_read2_b32 v[106:107], v29 offset0:162 offset1:163
    v_mfma_f32_16x16x32_bf16 a[216:219], v[160:163], v[204:207], a[216:219]
    buffer_load_dwordx4 v37, s[24:27], s73 offen offset:2048 lds
    v_mfma_f32_16x16x32_bf16 a[220:223], v[160:163], v[208:211], a[220:223]
    ds_read2_b32 v[108:109], v30 offset0:32 offset1:33
    s_waitcnt lgkmcnt(15)
    v_mfma_f32_16x16x32_bf16 a[208:211], v[164:167], v[192:195], a[208:211]
    ds_read2_b32 v[110:111], v30 offset0:34 offset1:35
    v_mfma_f32_16x16x32_bf16 a[212:215], v[164:167], v[196:199], a[212:215]
    ds_read2_b32 v[112:113], v30 offset0:160 offset1:161
    v_mfma_f32_16x16x32_bf16 a[216:219], v[164:167], v[200:203], a[216:219]
    s_add_u32 m0, s78, 86016
    s_add_u32 s73, s3, s85
    s_add_u32 s73, s73, 12
    s_and_b32 s73, s73, 15
    s_mul_i32 s73, s73, 114688
    s_add_u32 s73, s73, s79
    buffer_load_dwordx4 v31, s[24:27], s73 offen offset:0 lds
    ds_read2_b32 v[114:115], v30 offset0:162 offset1:163
    v_mfma_f32_16x16x32_bf16 a[220:223], v[164:167], v[204:207], a[220:223]
    s_waitcnt lgkmcnt(15)
    v_mfma_f32_16x16x32_bf16 a[212:215], v[168:171], v[192:195], a[212:215]
    v_mfma_f32_16x16x32_bf16 a[216:219], v[168:171], v[196:199], a[216:219]
    v_mfma_f32_16x16x32_bf16 a[220:223], v[168:171], v[200:203], a[220:223]
    s_waitcnt lgkmcnt(15)
    buffer_load_dwordx4 v32, s[24:27], s73 offen offset:1024 lds
    v_mfma_f32_16x16x32_bf16 a[216:219], v[172:175], v[192:195], a[216:219]
    v_mfma_f32_16x16x32_bf16 a[220:223], v[172:175], v[196:199], a[220:223]
    s_waitcnt lgkmcnt(15)
    v_mfma_f32_16x16x32_bf16 a[220:223], v[176:179], v[192:195], a[220:223]
    s_waitcnt lgkmcnt(14)
    v_mfma_f32_16x16x32_bf16 a[192:195], v[84:87], v[116:119], a[192:195]
    buffer_load_dwordx4 v33, s[24:27], s73 offen offset:2048 lds
    v_mfma_f32_16x16x32_bf16 a[196:199], v[84:87], v[120:123], a[196:199]
    v_mfma_f32_16x16x32_bf16 a[200:203], v[84:87], v[124:127], a[200:203]
    v_mfma_f32_16x16x32_bf16 a[204:207], v[84:87], v[128:131], a[204:207]
    v_mfma_f32_16x16x32_bf16 a[208:211], v[84:87], v[132:135], a[208:211]
    buffer_load_dwordx4 v34, s[24:27], s73 offen offset:3072 lds
    v_mfma_f32_16x16x32_bf16 a[212:215], v[84:87], v[136:139], a[212:215]
    v_mfma_f32_16x16x32_bf16 a[216:219], v[84:87], v[140:143], a[216:219]
    v_mfma_f32_16x16x32_bf16 a[220:223], v[84:87], v[144:147], a[220:223]
    s_waitcnt lgkmcnt(12)
    v_mfma_f32_16x16x32_bf16 a[196:199], v[88:91], v[116:119], a[196:199]
    s_add_u32 m0, s78, 90112
    s_nop 0
    buffer_load_dwordx4 v35, s[24:27], s73 offen offset:0 lds
    v_mfma_f32_16x16x32_bf16 a[200:203], v[88:91], v[120:123], a[200:203]
    v_mfma_f32_16x16x32_bf16 a[204:207], v[88:91], v[124:127], a[204:207]
    v_mfma_f32_16x16x32_bf16 a[208:211], v[88:91], v[128:131], a[208:211]
    v_mfma_f32_16x16x32_bf16 a[212:215], v[88:91], v[132:135], a[212:215]
    buffer_load_dwordx4 v36, s[24:27], s73 offen offset:1024 lds
    v_mfma_f32_16x16x32_bf16 a[216:219], v[88:91], v[136:139], a[216:219]
    v_mfma_f32_16x16x32_bf16 a[220:223], v[88:91], v[140:143], a[220:223]
    s_waitcnt lgkmcnt(10)
    v_mfma_f32_16x16x32_bf16 a[200:203], v[92:95], v[116:119], a[200:203]
    v_mfma_f32_16x16x32_bf16 a[204:207], v[92:95], v[120:123], a[204:207]
    buffer_load_dwordx4 v37, s[24:27], s73 offen offset:2048 lds
    v_mfma_f32_16x16x32_bf16 a[208:211], v[92:95], v[124:127], a[208:211]
    v_mfma_f32_16x16x32_bf16 a[212:215], v[92:95], v[128:131], a[212:215]
    v_mfma_f32_16x16x32_bf16 a[216:219], v[92:95], v[132:135], a[216:219]
    v_mfma_f32_16x16x32_bf16 a[220:223], v[92:95], v[136:139], a[220:223]
    s_waitcnt lgkmcnt(8)
    v_mfma_f32_16x16x32_bf16 a[204:207], v[96:99], v[116:119], a[204:207]
    v_mfma_f32_16x16x32_bf16 a[208:211], v[96:99], v[120:123], a[208:211]
    v_mfma_f32_16x16x32_bf16 a[212:215], v[96:99], v[124:127], a[212:215]
    v_mfma_f32_16x16x32_bf16 a[216:219], v[96:99], v[128:131], a[216:219]
    v_mfma_f32_16x16x32_bf16 a[220:223], v[96:99], v[132:135], a[220:223]
    s_waitcnt lgkmcnt(6)
    v_mfma_f32_16x16x32_bf16 a[208:211], v[100:103], v[116:119], a[208:211]
    v_mfma_f32_16x16x32_bf16 a[212:215], v[100:103], v[120:123], a[212:215]
    v_mfma_f32_16x16x32_bf16 a[216:219], v[100:103], v[124:127], a[216:219]
    v_mfma_f32_16x16x32_bf16 a[220:223], v[100:103], v[128:131], a[220:223]
    s_waitcnt lgkmcnt(4)
    v_mfma_f32_16x16x32_bf16 a[212:215], v[104:107], v[116:119], a[212:215]
    v_mfma_f32_16x16x32_bf16 a[216:219], v[104:107], v[120:123], a[216:219]
    v_mfma_f32_16x16x32_bf16 a[220:223], v[104:107], v[124:127], a[220:223]
    s_waitcnt lgkmcnt(2)
    v_mfma_f32_16x16x32_bf16 a[216:219], v[108:111], v[116:119], a[216:219]
    v_mfma_f32_16x16x32_bf16 a[220:223], v[108:111], v[120:123], a[220:223]
    s_waitcnt lgkmcnt(0)
    v_mfma_f32_16x16x32_bf16 a[220:223], v[112:115], v[116:119], a[220:223]
    v_lshrrev_b32 v1, 2, v4
    v_lshl_add_u32 v1, v5, 2, v1
    v_mul_u32_u24 v1, 224, v1
    v_add_u32 v38, v1, v10
    v_add_u32 v39, 57344, v38
    s_lshl_b32 s60, s3, 1
    s_min_u32 s60, s60, 5
    s_lshl_b32 s61, s60, 5
    v_add_u32 v40, s61, v38
    v_add_u32 v41, s61, v39
    s_lshl_b32 s60, s60, 6
    s_add_u32 s60, s60, 157696
    v_lshl_add_u32 v43, v5, 4, s60
    v_lshlrev_b32 v1, 4, v5
    v_add_u32 v44, 157696, v1
    v_and_b32 v2, 31, v3
    v_lshlrev_b32 v2, 2, v2
    v_lshrrev_b32 v1, 1, v5
    v_lshl_add_u32 v42, v1, 10, v2
    v_cmp_lt_u32 vcc, 7, v4
    v_mov_b32 v1, 0x05040100
    v_mov_b32 v2, 0x01000504
    v_cndmask_b32 v47, v1, v2, vcc
    v_add_u32 v48, 0x02020202, v47
    v_and_b32 v1, 7, v4
    v_lshl_add_u32 v1, v1, 2, v5
    v_mul_u32_u24 v1, 144, v1
    v_lshrrev_b32 v2, 3, v4
    v_lshl_add_u32 v1, v2, 6, v1
    s_lshl4_add_u32 s61, s62, s82
    v_add_u32 v45, s61, v1
    v_mul_u32_u24 v1, 144, v6
    v_lshl_add_u32 v1, v7, 4, v1
    s_mul_i32 s61, s62, 2304
    s_add_u32 s61, s61, s82
    v_add_u32 v46, s61, v1
    s_lshl2_add_u32 s58, s66, s3
    s_lshl_b32 s76, s58, 12
    s_add_u32 s76, s76, 0xf00000
    s_lshl_b32 s74, s58, 15
    s_add_u32 s74, s74, 0x200000
    s_lshl_b32 s75, s85, 10
    s_waitcnt vmcnt(0)
    s_cmp_eq_u32 s3, 0
    s_cbranch_scc0 L_skip_16
    v_and_b32 v1, 12, v0
    v_and_b32 v2, 3, v0
    v_lshlrev_b32 v1, 6, v1
    v_lshl_add_u32 v1, v2, 2, v1
    v_add_u32 v15, s87, v1
    s_mov_b32 s72, 32768
L_poll_17:
    buffer_load_dword v1, v15, s[36:39], 0 offen sc1
    s_sub_u32 s72, s72, 1
    s_cbranch_scc1 L_polled_18
    s_waitcnt vmcnt(0)
    v_cmp_ne_u32 vcc, s69, v1
    s_cbranch_vccnz L_poll_17
L_polled_18:
    s_waitcnt vmcnt(0)
L_skip_16:
    s_barrier
    s_add_u32 s77, s74, s75
    buffer_load_dwordx4 a[0:3], v11, s[36:39], s77 offen offset:0 sc1
    buffer_load_dwordx4 a[4:7], v12, s[36:39], s77 offen offset:0 sc1
    buffer_load_dwordx4 a[8:11], v11, s[36:39], s77 offen offset:1024 sc1
    buffer_load_dwordx4 a[12:15], v12, s[36:39], s77 offen offset:1024 sc1
    s_add_u32 s75, s75, 2048
    s_and_b32 s75, s75, 0x3fff
    s_add_u32 s77, s74, s75
    buffer_load_dwordx4 a[16:19], v11, s[36:39], s77 offen offset:0 sc1
    buffer_load_dwordx4 a[20:23], v12, s[36:39], s77 offen offset:0 sc1
    ds_read_b64_tr_b16 v[116:117], v40 offset:0
    ds_read_b64_tr_b16 v[118:119], v40 offset:3584
    ds_read_b64_tr_b16 v[120:121], v40 offset:32
    ds_read_b64_tr_b16 v[122:123], v40 offset:3616
    ds_read_b64_tr_b16 v[124:125], v40 offset:7168
    ds_read_b64_tr_b16 v[126:127], v40 offset:10752
    ds_read_b64_tr_b16 v[128:129], v40 offset:7200
    ds_read_b64_tr_b16 v[130:131], v40 offset:10784
    ds_read_b64_tr_b16 v[132:133], v40 offset:14336
    ds_read_b64_tr_b16 v[134:135], v40 offset:17920
    ds_read_b64_tr_b16 v[136:137], v40 offset:14368
    ds_read_b64_tr_b16 v[138:139], v40 offset:17952
    ds_read_b64_tr_b16 v[192:193], v40 offset:21504
    ds_read_b64_tr_b16 v[194:195], v40 offset:25088
    ds_read_b64_tr_b16 v[196:197], v40 offset:21536
    ds_read_b64_tr_b16 v[198:199], v40 offset:25120
    ds_read_b64_tr_b16 v[200:201], v40 offset:28672
    ds_read_b64_tr_b16 v[202:203], v40 offset:32256
    ds_read_b64_tr_b16 v[204:205], v40 offset:28704
    ds_read_b64_tr_b16 v[206:207], v40 offset:32288
    s_waitcnt lgkmcnt(15)
    v_mfma_f32_16x16x32_bf16 v[164:167], v[116:119], v[56:59], 0
    ds_read_b64_tr_b16 v[208:209], v40 offset:35840
    ds_read_b64_tr_b16 v[210:211], v40 offset:39424
    v_mfma_f32_16x16x32_bf16 v[168:171], v[120:123], v[56:59], 0
    ds_read_b64_tr_b16 v[212:213], v40 offset:35872
    ds_read_b64_tr_b16 v[214:215], v40 offset:39456
    s_waitcnt lgkmcnt(15)
    v_mfma_f32_16x16x32_bf16 v[164:167], v[124:127], v[56:59], v[164:167]
    ds_read_b64_tr_b16 v[220:221], v40 offset:43008
    ds_read_b64_tr_b16 v[222:223], v40 offset:46592
    v_mfma_f32_16x16x32_bf16 v[168:171], v[128:131], v[56:59], v[168:171]
    ds_read_b64_tr_b16 v[224:225], v40 offset:43040
    ds_read_b64_tr_b16 v[226:227], v40 offset:46624
    s_waitcnt lgkmcnt(15)
    v_mfma_f32_16x16x32_bf16 v[164:167], v[132:135], v[56:59], v[164:167]
    ds_read_b64_tr_b16 v[228:229], v40 offset:50176
    ds_read_b64_tr_b16 v[230:231], v40 offset:53760
    v_mfma_f32_16x16x32_bf16 v[168:171], v[136:139], v[56:59], v[168:171]
    ds_read_b64_tr_b16 v[232:233], v40 offset:50208
    ds_read_b64_tr_b16 v[234:235], v40 offset:53792
    s_waitcnt lgkmcnt(15)
    v_mfma_f32_16x16x32_bf16 v[164:167], v[192:195], v[56:59], v[164:167]
    ds_read_b64_tr_b16 v[116:117], v41 offset:0
    ds_read_b64_tr_b16 v[118:119], v41 offset:3584
    v_mfma_f32_16x16x32_bf16 v[168:171], v[196:199], v[56:59], v[168:171]
    buffer_load_dwordx4 a[24:27], v11, s[36:39], s77 offen offset:1024 sc1
    ds_read_b64_tr_b16 v[120:121], v41 offset:32
    ds_read_b64_tr_b16 v[122:123], v41 offset:3616
    s_waitcnt lgkmcnt(15)
    v_mfma_f32_16x16x32_bf16 v[164:167], v[200:203], v[56:59], v[164:167]
    ds_read_b64_tr_b16 v[124:125], v41 offset:7168
    ds_read_b64_tr_b16 v[126:127], v41 offset:10752
    v_mfma_f32_16x16x32_bf16 v[168:171], v[204:207], v[56:59], v[168:171]
    ds_read_b64_tr_b16 v[128:129], v41 offset:7200
    ds_read_b64_tr_b16 v[130:131], v41 offset:10784
    s_waitcnt lgkmcnt(15)
    v_mfma_f32_16x16x32_bf16 v[164:167], v[208:211], v[56:59], v[164:167]
    ds_read_b64_tr_b16 v[132:133], v41 offset:14336
    ds_read_b64_tr_b16 v[134:135], v41 offset:17920
    v_mfma_f32_16x16x32_bf16 v[168:171], v[212:215], v[56:59], v[168:171]
    ds_read_b64_tr_b16 v[136:137], v41 offset:14368
    ds_read_b64_tr_b16 v[138:139], v41 offset:17952
    s_waitcnt lgkmcnt(15)
    v_mfma_f32_16x16x32_bf16 v[164:167], v[220:223], v[56:59], v[164:167]
    ds_read_b64_tr_b16 v[192:193], v41 offset:21504
    ds_read_b64_tr_b16 v[194:195], v41 offset:25088
    v_mfma_f32_16x16x32_bf16 v[168:171], v[224:227], v[56:59], v[168:171]
    ds_read_b64_tr_b16 v[196:197], v41 offset:21536
    ds_read_b64_tr_b16 v[198:199], v41 offset:25120
    s_waitcnt lgkmcnt(15)
    v_mfma_f32_16x16x32_bf16 v[164:167], v[228:231], v[56:59], v[164:167]
    ds_read_b64_tr_b16 v[200:201], v41 offset:28672
    ds_read_b64_tr_b16 v[202:203], v41 offset:32256
    v_mfma_f32_16x16x32_bf16 v[168:171], v[232:235], v[56:59], v[168:171]
    buffer_load_dwordx4 a[28:31], v12, s[36:39], s77 offen offset:1024 sc1
    ds_read_b64_tr_b16 v[204:205], v41 offset:28704
    ds_read_b64_tr_b16 v[206:207], v41 offset:32288
    s_waitcnt lgkmcnt(15)
    v_mfma_f32_16x16x32_bf16 v[164:167], v[116:119], v[56:59], v[164:167]
    ds_read_b64_tr_b16 v[208:209], v41 offset:35840
    ds_read_b64_tr_b16 v[210:211], v41 offset:39424
    v_mfma_f32_16x16x32_bf16 v[168:171], v[120:123], v[56:59], v[168:171]
    ds_read_b64_tr_b16 v[212:213], v41 offset:35872
    ds_read_b64_tr_b16 v[214:215], v41 offset:39456
    s_waitcnt lgkmcnt(15)
    v_mfma_f32_16x16x32_bf16 v[164:167], v[124:127], v[56:59], v[164:167]
    ds_read_b64_tr_b16 v[220:221], v41 offset:43008
    ds_read_b64_tr_b16 v[222:223], v41 offset:46592
    v_mfma_f32_16x16x32_bf16 v[168:171], v[128:131], v[56:59], v[168:171]
    ds_read_b64_tr_b16 v[224:225], v41 offset:43040
    ds_read_b64_tr_b16 v[226:227], v41 offset:46624
    s_waitcnt lgkmcnt(15)
    v_mfma_f32_16x16x32_bf16 v[164:167], v[132:135], v[56:59], v[164:167]
    ds_read_b64_tr_b16 v[228:229], v41 offset:50176
    ds_read_b64_tr_b16 v[230:231], v41 offset:53760
    v_mfma_f32_16x16x32_bf16 v[168:171], v[136:139], v[56:59], v[168:171]
    ds_read_b64_tr_b16 v[232:233], v41 offset:50208
    ds_read_b64_tr_b16 v[234:235], v41 offset:53792
    s_waitcnt lgkmcnt(15)
    v_mfma_f32_16x16x32_bf16 v[164:167], v[192:195], v[56:59], v[164:167]
    ds_read_b64_tr_b16 v[84:85], v38 offset:0
    ds_read_b64_tr_b16 v[86:87], v38 offset:3584
    v_mfma_f32_16x16x32_bf16 v[168:171], v[196:199], v[56:59], v[168:171]
    s_add_u32 s75, s75, 2048
    s_and_b32 s75, s75, 0x3fff
    s_add_u32 s77, s74, s75
    buffer_load_dwordx4 a[32:35], v11, s[36:39], s77 offen offset:0 sc1
    ds_read_b64_tr_b16 v[88:89], v38 offset:32
    ds_read_b64_tr_b16 v[90:91], v38 offset:3616
    s_waitcnt lgkmcnt(15)
    v_mfma_f32_16x16x32_bf16 v[164:167], v[200:203], v[56:59], v[164:167]
    ds_read_b64_tr_b16 v[92:93], v38 offset:64
    ds_read_b64_tr_b16 v[94:95], v38 offset:3648
    v_mfma_f32_16x16x32_bf16 v[168:171], v[204:207], v[56:59], v[168:171]
    ds_read_b64_tr_b16 v[96:97], v38 offset:96
    ds_read_b64_tr_b16 v[98:99], v38 offset:3680
    s_waitcnt lgkmcnt(15)
    v_mfma_f32_16x16x32_bf16 v[164:167], v[208:211], v[56:59], v[164:167]
    ds_read_b64_tr_b16 v[100:101], v38 offset:128
    ds_read_b64_tr_b16 v[102:103], v38 offset:3712
    v_mfma_f32_16x16x32_bf16 v[168:171], v[212:215], v[56:59], v[168:171]
    ds_read_b64_tr_b16 v[104:105], v38 offset:160
    ds_read_b64_tr_b16 v[106:107], v38 offset:3744
    s_waitcnt lgkmcnt(15)
    v_mfma_f32_16x16x32_bf16 v[164:167], v[220:223], v[56:59], v[164:167]
    ds_read_b64_tr_b16 v[108:109], v38 offset:192
    v_mfma_f32_16x16x32_bf16 v[168:171], v[224:227], v[56:59], v[168:171]
    ds_read_b64_tr_b16 v[110:111], v38 offset:3776
    s_waitcnt lgkmcnt(14)
    v_mfma_f32_16x16x32_bf16 v[164:167], v[228:231], v[56:59], v[164:167]
    v_mfma_f32_16x16x32_bf16 v[168:171], v[232:235], v[56:59], v[168:171]
    s_mov_b32 exec_lo, 0x00010001
    s_mov_b32 exec_hi, 0x00010001
    s_nop 4
    ds_write_b128 v43, v[164:167] offset:0
    ds_write_b128 v43, v[168:171] offset:64
    s_mov_b64 exec, -1
    s_waitcnt vmcnt(7) lgkmcnt(8)
    buffer_load_dwordx4 a[36:39], v12, s[36:39], s77 offen offset:0 sc1
    v_mfma_f32_16x16x32_bf16 v[192:195], v[84:87], a[0:3], 0
    ds_read_b64_tr_b16 v[116:117], v38 offset:7168
    v_mfma_f32_16x16x32_bf16 v[220:223], v[84:87], a[4:7], 0
    ds_read_b64_tr_b16 v[118:119], v38 offset:10752
    v_mfma_f32_16x16x32_bf16 v[196:199], v[88:91], a[0:3], 0
    ds_read_b64_tr_b16 v[120:121], v38 offset:7200
    v_mfma_f32_16x16x32_bf16 v[224:227], v[88:91], a[4:7], 0
    ds_read_b64_tr_b16 v[122:123], v38 offset:10784
    v_mfma_f32_16x16x32_bf16 v[200:203], v[92:95], a[0:3], 0
    buffer_load_dwordx4 a[40:43], v11, s[36:39], s77 offen offset:1024 sc1
    ds_read_b64_tr_b16 v[124:125], v38 offset:7232
    v_mfma_f32_16x16x32_bf16 v[228:231], v[92:95], a[4:7], 0
    ds_read_b64_tr_b16 v[126:127], v38 offset:10816
    v_mfma_f32_16x16x32_bf16 v[204:207], v[96:99], a[0:3], 0
    ds_read_b64_tr_b16 v[128:129], v38 offset:7264
    v_mfma_f32_16x16x32_bf16 v[232:235], v[96:99], a[4:7], 0
    ds_read_b64_tr_b16 v[130:131], v38 offset:10848
    s_waitcnt lgkmcnt(10)
    v_mfma_f32_16x16x32_bf16 v[208:211], v[100:103], a[0:3], 0
    ds_read_b64_tr_b16 v[132:133], v38 offset:7296
    v_mfma_f32_16x16x32_bf16 v[236:239], v[100:103], a[4:7], 0
    buffer_load_dwordx4 a[44:47], v12, s[36:39], s77 offen offset:1024 sc1
    ds_read_b64_tr_b16 v[134:135], v38 offset:10880
    v_mfma_f32_16x16x32_bf16 v[212:215], v[104:107], a[0:3], 0
    ds_read_b64_tr_b16 v[136:137], v38 offset:7328
    v_mfma_f32_16x16x32_bf16 v[240:243], v[104:107], a[4:7], 0
    ds_read_b64_tr_b16 v[138:139], v38 offset:10912
    v_mfma_f32_16x16x32_bf16 v[216:219], v[108:111], a[0:3], 0
    ds_read_b64_tr_b16 v[140:141], v38 offset:7360
    v_mfma_f32_16x16x32_bf16 v[244:247], v[108:111], a[4:7], 0
    ds_read_b64_tr_b16 v[142:143], v38 offset:10944
    s_waitcnt vmcnt(8) lgkmcnt(0)
    s_barrier
    v_mfma_f32_16x16x32_bf16 v[192:195], v[116:119], a[8:11], v[192:195]
    buffer_load_dword v148, v42, s[36:39], s76 offen offset:0 sc1
    ds_read_b64_tr_b16 v[84:85], v38 offset:14336
    ds_read_b64_tr_b16 v[86:87], v38 offset:17920
    v_mfma_f32_16x16x32_bf16 v[220:223], v[116:119], a[12:15], v[220:223]
    ds_read_b128 v[164:167], v44 offset:0
    v_mfma_f32_16x16x32_bf16 v[196:199], v[120:123], a[8:11], v[196:199]
    buffer_load_dword v149, v42, s[36:39], s76 offen offset:128 sc1
    ds_read_b64_tr_b16 v[88:89], v38 offset:14368
    ds_read_b64_tr_b16 v[90:91], v38 offset:17952
    v_mfma_f32_16x16x32_bf16 v[224:227], v[120:123], a[12:15], v[224:227]
    ds_read_b128 v[168:171], v44 offset:64
    v_mfma_f32_16x16x32_bf16 v[200:203], v[124:127], a[8:11], v[200:203]
    buffer_load_dword v150, v42, s[36:39], s76 offen offset:256 sc1
    ds_read_b64_tr_b16 v[92:93], v38 offset:14400
    ds_read_b64_tr_b16 v[94:95], v38 offset:17984
    v_mfma_f32_16x16x32_bf16 v[228:231], v[124:127], a[12:15], v[228:231]
    ds_read_b128 v[172:175], v44 offset:128
    v_mfma_f32_16x16x32_bf16 v[204:207], v[128:131], a[8:11], v[204:207]
    buffer_load_dword v151, v42, s[36:39], s76 offen offset:384 sc1
    ds_read_b64_tr_b16 v[96:97], v38 offset:14432
    ds_read_b64_tr_b16 v[98:99], v38 offset:18016
    v_mfma_f32_16x16x32_bf16 v[232:235], v[128:131], a[12:15], v[232:235]
    ds_read_b128 v[176:179], v44 offset:192
    v_mfma_f32_16x16x32_bf16 v[208:211], v[132:135], a[8:11], v[208:211]
    buffer_load_dword v152, v42, s[36:39], s76 offen offset:512 sc1
    ds_read_b64_tr_b16 v[100:101], v38 offset:14464
    ds_read_b64_tr_b16 v[102:103], v38 offset:18048
    v_mfma_f32_16x16x32_bf16 v[236:239], v[132:135], a[12:15], v[236:239]
    ds_read_b128 v[180:183], v44 offset:256
    v_mfma_f32_16x16x32_bf16 v[212:215], v[136:139], a[8:11], v[212:215]
    buffer_load_dword v153, v42, s[36:39], s76 offen offset:640 sc1
    ds_read_b64_tr_b16 v[104:105], v38 offset:14496
    ds_read_b64_tr_b16 v[106:107], v38 offset:18080
    v_mfma_f32_16x16x32_bf16 v[240:243], v[136:139], a[12:15], v[240:243]
    ds_read_b128 v[184:187], v44 offset:320
    v_mfma_f32_16x16x32_bf16 v[216:219], v[140:143], a[8:11], v[216:219]
    buffer_load_dword v154, v42, s[36:39], s76 offen offset:768 sc1
    ds_read_b64_tr_b16 v[108:109], v38 offset:14528
    ds_read_b64_tr_b16 v[110:111], v38 offset:18112
    v_mfma_f32_16x16x32_bf16 v[244:247], v[140:143], a[12:15], v[244:247]
    ds_read_b128 v[188:191], v44 offset:384
    s_waitcnt vmcnt(13) lgkmcnt(10)
    v_mfma_f32_16x16x32_bf16 v[192:195], v[84:87], a[16:19], v[192:195]
    buffer_load_dword v155, v42, s[36:39], s76 offen offset:896 sc1
    ds_read_b64_tr_b16 v[116:117], v38 offset:21504
    v_mfma_f32_16x16x32_bf16 v[220:223], v[84:87], a[20:23], v[220:223]
    ds_read_b64_tr_b16 v[118:119], v38 offset:25088
    v_mfma_f32_16x16x32_bf16 v[196:199], v[88:91], a[16:19], v[196:199]
    buffer_load_dword v156, v42, s[36:39], s76 offen offset:2048 sc1
    ds_read_b64_tr_b16 v[120:121], v38 offset:21536
    v_mfma_f32_16x16x32_bf16 v[224:227], v[88:91], a[20:23], v[224:227]
    ds_read_b64_tr_b16 v[122:123], v38 offset:25120
    v_mfma_f32_16x16x32_bf16 v[200:203], v[92:95], a[16:19], v[200:203]
    buffer_load_dword v157, v42, s[36:39], s76 offen offset:2176 sc1
    ds_read_b64_tr_b16 v[124:125], v38 offset:21568
    v_mfma_f32_16x16x32_bf16 v[228:231], v[92:95], a[20:23], v[228:231]
    ds_read_b64_tr_b16 v[126:127], v38 offset:25152
    v_mfma_f32_16x16x32_bf16 v[204:207], v[96:99], a[16:19], v[204:207]
    buffer_load_dword v158, v42, s[36:39], s76 offen offset:2304 sc1
    ds_read_b64_tr_b16 v[128:129], v38 offset:21600
    v_mfma_f32_16x16x32_bf16 v[232:235], v[96:99], a[20:23], v[232:235]
    ds_read_b64_tr_b16 v[130:131], v38 offset:25184
    s_waitcnt lgkmcnt(9)
    v_mfma_f32_16x16x32_bf16 v[208:211], v[100:103], a[16:19], v[208:211]
    buffer_load_dword v159, v42, s[36:39], s76 offen offset:2432 sc1
    ds_read_b64_tr_b16 v[132:133], v38 offset:21632
    v_mfma_f32_16x16x32_bf16 v[236:239], v[100:103], a[20:23], v[236:239]
    ds_read_b64_tr_b16 v[134:135], v38 offset:25216
    v_mfma_f32_16x16x32_bf16 v[212:215], v[104:107], a[16:19], v[212:215]
    buffer_load_dword v160, v42, s[36:39], s76 offen offset:2560 sc1
    ds_read_b64_tr_b16 v[136:137], v38 offset:21664
    v_mfma_f32_16x16x32_bf16 v[240:243], v[104:107], a[20:23], v[240:243]
    ds_read_b64_tr_b16 v[138:139], v38 offset:25248
    v_mfma_f32_16x16x32_bf16 v[216:219], v[108:111], a[16:19], v[216:219]
    buffer_load_dword v161, v42, s[36:39], s76 offen offset:2688 sc1
    ds_read_b64_tr_b16 v[140:141], v38 offset:21696
    v_mfma_f32_16x16x32_bf16 v[244:247], v[108:111], a[20:23], v[244:247]
    ds_read_b64_tr_b16 v[142:143], v38 offset:25280
    s_waitcnt vmcnt(18) lgkmcnt(6)
    v_mfma_f32_16x16x32_bf16 v[192:195], v[116:119], a[24:27], v[192:195]
    buffer_load_dword v162, v42, s[36:39], s76 offen offset:2816 sc1
    ds_read_b64_tr_b16 v[84:85], v38 offset:28672
    v_mfma_f32_16x16x32_bf16 v[220:223], v[116:119], a[28:31], v[220:223]
    ds_read_b64_tr_b16 v[86:87], v38 offset:32256
    v_mfma_f32_16x16x32_bf16 v[196:199], v[120:123], a[24:27], v[196:199]
    buffer_load_dword v163, v42, s[36:39], s76 offen offset:2944 sc1
    ds_read_b64_tr_b16 v[88:89], v38 offset:28704
    v_mfma_f32_16x16x32_bf16 v[224:227], v[120:123], a[28:31], v[224:227]
    ds_read_b64_tr_b16 v[90:91], v38 offset:32288
    v_mfma_f32_16x16x32_bf16 v[200:203], v[124:127], a[24:27], v[200:203]
    s_add_u32 s75, s75, 2048
    s_and_b32 s75, s75, 0x3fff
    s_add_u32 s77, s74, s75
    buffer_load_dwordx4 a[48:51], v11, s[36:39], s77 offen offset:0 sc1
    ds_read_b64_tr_b16 v[92:93], v38 offset:28736
    v_mfma_f32_16x16x32_bf16 v[228:231], v[124:127], a[28:31], v[228:231]
    ds_read_b64_tr_b16 v[94:95], v38 offset:32320
    v_mfma_f32_16x16x32_bf16 v[204:207], v[128:131], a[24:27], v[204:207]
    ds_read_b64_tr_b16 v[96:97], v38 offset:28768
    v_mfma_f32_16x16x32_bf16 v[232:235], v[128:131], a[28:31], v[232:235]
    ds_read_b64_tr_b16 v[98:99], v38 offset:32352
    s_waitcnt lgkmcnt(8)
    v_mfma_f32_16x16x32_bf16 v[208:211], v[132:135], a[24:27], v[208:211]
    ds_read_b64_tr_b16 v[100:101], v38 offset:28800
    v_mfma_f32_16x16x32_bf16 v[236:239], v[132:135], a[28:31], v[236:239]
    buffer_load_dwordx4 a[52:55], v12, s[36:39], s77 offen offset:0 sc1
    ds_read_b64_tr_b16 v[102:103], v38 offset:32384
    v_mfma_f32_16x16x32_bf16 v[212:215], v[136:139], a[24:27], v[212:215]
    ds_read_b64_tr_b16 v[104:105], v38 offset:28832
    v_mfma_f32_16x16x32_bf16 v[240:243], v[136:139], a[28:31], v[240:243]
    ds_read_b64_tr_b16 v[106:107], v38 offset:32416
    v_mfma_f32_16x16x32_bf16 v[216:219], v[140:143], a[24:27], v[216:219]
    ds_read_b64_tr_b16 v[108:109], v38 offset:28864
    v_mfma_f32_16x16x32_bf16 v[244:247], v[140:143], a[28:31], v[244:247]
    ds_read_b64_tr_b16 v[110:111], v38 offset:32448
    s_waitcnt vmcnt(20) lgkmcnt(6)
    v_mfma_f32_16x16x32_bf16 v[192:195], v[84:87], a[32:35], v[192:195]
    buffer_load_dwordx4 a[56:59], v11, s[36:39], s77 offen offset:1024 sc1
    ds_read_b64_tr_b16 v[116:117], v38 offset:35840
    v_mfma_f32_16x16x32_bf16 v[220:223], v[84:87], a[36:39], v[220:223]
    ds_read_b64_tr_b16 v[118:119], v38 offset:39424
    v_mfma_f32_16x16x32_bf16 v[196:199], v[88:91], a[32:35], v[196:199]
    ds_read_b64_tr_b16 v[120:121], v38 offset:35872
    v_mfma_f32_16x16x32_bf16 v[224:227], v[88:91], a[36:39], v[224:227]
    ds_read_b64_tr_b16 v[122:123], v38 offset:39456
    v_mfma_f32_16x16x32_bf16 v[200:203], v[92:95], a[32:35], v[200:203]
    ds_read_b64_tr_b16 v[124:125], v38 offset:35904
    v_mfma_f32_16x16x32_bf16 v[228:231], v[92:95], a[36:39], v[228:231]
    buffer_load_dwordx4 a[60:63], v12, s[36:39], s77 offen offset:1024 sc1
    ds_read_b64_tr_b16 v[126:127], v38 offset:39488
    v_mfma_f32_16x16x32_bf16 v[204:207], v[96:99], a[32:35], v[204:207]
    ds_read_b64_tr_b16 v[128:129], v38 offset:35936
    v_mfma_f32_16x16x32_bf16 v[232:235], v[96:99], a[36:39], v[232:235]
    ds_read_b64_tr_b16 v[130:131], v38 offset:39520
    s_waitcnt lgkmcnt(8)
    v_mfma_f32_16x16x32_bf16 v[208:211], v[100:103], a[32:35], v[208:211]
    ds_read_b64_tr_b16 v[132:133], v38 offset:35968
    v_mfma_f32_16x16x32_bf16 v[236:239], v[100:103], a[36:39], v[236:239]
    ds_read_b64_tr_b16 v[134:135], v38 offset:39552
    v_mfma_f32_16x16x32_bf16 v[212:215], v[104:107], a[32:35], v[212:215]
    s_add_u32 s75, s75, 2048
    s_and_b32 s75, s75, 0x3fff
    s_add_u32 s77, s74, s75
    buffer_load_dwordx4 a[64:67], v11, s[36:39], s77 offen offset:0 sc1
    ds_read_b64_tr_b16 v[136:137], v38 offset:36000
    v_mfma_f32_16x16x32_bf16 v[240:243], v[104:107], a[36:39], v[240:243]
    ds_read_b64_tr_b16 v[138:139], v38 offset:39584
    v_mfma_f32_16x16x32_bf16 v[216:219], v[108:111], a[32:35], v[216:219]
    ds_read_b64_tr_b16 v[140:141], v38 offset:36032
    v_mfma_f32_16x16x32_bf16 v[244:247], v[108:111], a[36:39], v[244:247]
    ds_read_b64_tr_b16 v[142:143], v38 offset:39616
    s_waitcnt vmcnt(21) lgkmcnt(6)
    s_waitcnt vmcnt(5)
    v_mfma_f32_16x16x32_bf16 v[192:195], v[116:119], a[40:43], v[192:195]
    ds_read_b64_tr_b16 v[84:85], v38 offset:43008
    ds_read_b64_tr_b16 v[86:87], v38 offset:46592
    v_mfma_f32_16x16x32_bf16 v[220:223], v[116:119], a[44:47], v[220:223]
    buffer_load_dwordx4 a[68:71], v12, s[36:39], s77 offen offset:0 sc1
    v_add_f32 v148, v148, v149
    v_mfma_f32_16x16x32_bf16 v[196:199], v[120:123], a[40:43], v[196:199]
    ds_read_b64_tr_b16 v[88:89], v38 offset:43040
    ds_read_b64_tr_b16 v[90:91], v38 offset:46624
    v_mfma_f32_16x16x32_bf16 v[224:227], v[120:123], a[44:47], v[224:227]
    v_add_f32 v148, v148, v150
    v_mfma_f32_16x16x32_bf16 v[200:203], v[124:127], a[40:43], v[200:203]
    ds_read_b64_tr_b16 v[92:93], v38 offset:43072
    ds_read_b64_tr_b16 v[94:95], v38 offset:46656
    v_mfma_f32_16x16x32_bf16 v[228:231], v[124:127], a[44:47], v[228:231]
    v_add_f32 v148, v148, v151
    v_mfma_f32_16x16x32_bf16 v[204:207], v[128:131], a[40:43], v[204:207]
    buffer_load_dwordx4 a[72:75], v11, s[36:39], s77 offen offset:1024 sc1
    ds_read_b64_tr_b16 v[96:97], v38 offset:43104
    v_mfma_f32_16x16x32_bf16 v[232:235], v[128:131], a[44:47], v[232:235]
    ds_read_b64_tr_b16 v[98:99], v38 offset:46688
    v_add_f32 v148, v148, v152
    s_waitcnt lgkmcnt(8)
    v_mfma_f32_16x16x32_bf16 v[208:211], v[132:135], a[40:43], v[208:211]
    ds_read_b64_tr_b16 v[100:101], v38 offset:43136
    v_mfma_f32_16x16x32_bf16 v[236:239], v[132:135], a[44:47], v[236:239]
    ds_read_b64_tr_b16 v[102:103], v38 offset:46720
    v_add_f32 v148, v148, v153
    v_mfma_f32_16x16x32_bf16 v[212:215], v[136:139], a[40:43], v[212:215]
    ds_read_b64_tr_b16 v[104:105], v38 offset:43168
    v_mfma_f32_16x16x32_bf16 v[240:243], v[136:139], a[44:47], v[240:243]
    buffer_load_dwordx4 a[76:79], v12, s[36:39], s77 offen offset:1024 sc1
    ds_read_b64_tr_b16 v[106:107], v38 offset:46752
    v_add_f32 v148, v148, v154
    v_mfma_f32_16x16x32_bf16 v[216:219], v[140:143], a[40:43], v[216:219]
    ds_read_b64_tr_b16 v[108:109], v38 offset:43200
    v_mfma_f32_16x16x32_bf16 v[244:247], v[140:143], a[44:47], v[244:247]
    ds_read_b64_tr_b16 v[110:111], v38 offset:46784
    s_waitcnt vmcnt(6) lgkmcnt(6)
    v_mfma_f32_16x16x32_bf16 v[192:195], v[84:87], a[48:51], v[192:195]
    ds_read_b64_tr_b16 v[116:117], v38 offset:50176
    ds_read_b64_tr_b16 v[118:119], v38 offset:53760
    v_mfma_f32_16x16x32_bf16 v[220:223], v[84:87], a[52:55], v[220:223]
    v_add_f32 v148, v148, v155
    v_mfma_f32_16x16x32_bf16 v[196:199], v[88:91], a[48:51], v[196:199]
    s_add_u32 s75, s75, 2048
    s_and_b32 s75, s75, 0x3fff
    s_add_u32 s77, s74, s75
    buffer_load_dwordx4 a[80:83], v11, s[36:39], s77 offen offset:0 sc1
    ds_read_b64_tr_b16 v[120:121], v38 offset:50208
    ds_read_b64_tr_b16 v[122:123], v38 offset:53792
    v_mfma_f32_16x16x32_bf16 v[224:227], v[88:91], a[52:55], v[224:227]
    v_mov_b32 v149, v148
    v_mfma_f32_16x16x32_bf16 v[200:203], v[92:95], a[48:51], v[200:203]
    ds_read_b64_tr_b16 v[124:125], v38 offset:50240
    ds_read_b64_tr_b16 v[126:127], v38 offset:53824
    v_mfma_f32_16x16x32_bf16 v[228:231], v[92:95], a[52:55], v[228:231]
    v_add_f32 v156, v156, v157
    v_mfma_f32_16x16x32_bf16 v[204:207], v[96:99], a[48:51], v[204:207]
    ds_read_b64_tr_b16 v[128:129], v38 offset:50272
    v_mfma_f32_16x16x32_bf16 v[232:235], v[96:99], a[52:55], v[232:235]
    buffer_load_dwordx4 a[84:87], v12, s[36:39], s77 offen offset:0 sc1
    ds_read_b64_tr_b16 v[130:131], v38 offset:53856
    v_add_f32 v156, v156, v158
    s_waitcnt lgkmcnt(8)
    v_mfma_f32_16x16x32_bf16 v[208:211], v[100:103], a[48:51], v[208:211]
    ds_read_b64_tr_b16 v[132:133], v38 offset:50304
    v_mfma_f32_16x16x32_bf16 v[236:239], v[100:103], a[52:55], v[236:239]
    ds_read_b64_tr_b16 v[134:135], v38 offset:53888
    v_add_f32 v156, v156, v159
    v_mfma_f32_16x16x32_bf16 v[212:215], v[104:107], a[48:51], v[212:215]
    ds_read_b64_tr_b16 v[136:137], v38 offset:50336
    v_mfma_f32_16x16x32_bf16 v[240:243], v[104:107], a[52:55], v[240:243]
    ds_read_b64_tr_b16 v[138:139], v38 offset:53920
    v_add_f32 v156, v156, v160
    v_mfma_f32_16x16x32_bf16 v[216:219], v[108:111], a[48:51], v[216:219]
    buffer_load_dwordx4 a[88:91], v11, s[36:39], s77 offen offset:1024 sc1
    ds_read_b64_tr_b16 v[140:141], v38 offset:50368
    v_mfma_f32_16x16x32_bf16 v[244:247], v[108:111], a[52:55], v[244:247]
    ds_read_b64_tr_b16 v[142:143], v38 offset:53952
    s_waitcnt vmcnt(7) lgkmcnt(6)
    v_mfma_f32_16x16x32_bf16 v[192:195], v[116:119], a[56:59], v[192:195]
    ds_read_b64_tr_b16 v[84:85], v39 offset:0
    ds_read_b64_tr_b16 v[86:87], v39 offset:3584
    v_mfma_f32_16x16x32_bf16 v[220:223], v[116:119], a[60:63], v[220:223]
    v_add_f32 v156, v156, v161
    v_mfma_f32_16x16x32_bf16 v[196:199], v[120:123], a[56:59], v[196:199]
    ds_read_b64_tr_b16 v[88:89], v39 offset:32
    ds_read_b64_tr_b16 v[90:91], v39 offset:3616
    v_mfma_f32_16x16x32_bf16 v[224:227], v[120:123], a[60:63], v[224:227]
    buffer_load_dwordx4 a[92:95], v12, s[36:39], s77 offen offset:1024 sc1
    v_add_f32 v156, v156, v162
    v_mfma_f32_16x16x32_bf16 v[200:203], v[124:127], a[56:59], v[200:203]
    ds_read_b64_tr_b16 v[92:93], v39 offset:64
    ds_read_b64_tr_b16 v[94:95], v39 offset:3648
    v_mfma_f32_16x16x32_bf16 v[228:231], v[124:127], a[60:63], v[228:231]
    v_add_f32 v156, v156, v163
    v_mfma_f32_16x16x32_bf16 v[204:207], v[128:131], a[56:59], v[204:207]
    ds_read_b64_tr_b16 v[96:97], v39 offset:96
    v_mfma_f32_16x16x32_bf16 v[232:235], v[128:131], a[60:63], v[232:235]
    ds_read_b64_tr_b16 v[98:99], v39 offset:3680
    v_mov_b32 v157, v156
    s_waitcnt lgkmcnt(8)
    v_mfma_f32_16x16x32_bf16 v[208:211], v[132:135], a[56:59], v[208:211]
    s_add_u32 s75, s75, 2048
    s_and_b32 s75, s75, 0x3fff
    s_add_u32 s77, s74, s75
    buffer_load_dwordx4 a[96:99], v11, s[36:39], s77 offen offset:0 sc1
    ds_read_b64_tr_b16 v[100:101], v39 offset:128
    v_mfma_f32_16x16x32_bf16 v[236:239], v[132:135], a[60:63], v[236:239]
    ds_read_b64_tr_b16 v[102:103], v39 offset:3712
    v_permlane32_swap_b32 v149, v148
    v_mfma_f32_16x16x32_bf16 v[212:215], v[136:139], a[56:59], v[212:215]
    ds_read_b64_tr_b16 v[104:105], v39 offset:160
    v_mfma_f32_16x16x32_bf16 v[240:243], v[136:139], a[60:63], v[240:243]
    ds_read_b64_tr_b16 v[106:107], v39 offset:3744
    v_permlane32_swap_b32 v157, v156
    v_mfma_f32_16x16x32_bf16 v[216:219], v[140:143], a[56:59], v[216:219]
    ds_read_b64_tr_b16 v[108:109], v39 offset:192
    v_mfma_f32_16x16x32_bf16 v[244:247], v[140:143], a[60:63], v[244:247]
    buffer_load_dwordx4 a[100:103], v12, s[36:39], s77 offen offset:0 sc1
    ds_read_b64_tr_b16 v[110:111], v39 offset:3776
    s_waitcnt vmcnt(8) lgkmcnt(6)
    v_mfma_f32_16x16x32_bf16 v[192:195], v[84:87], a[64:67], v[192:195]
    ds_read_b64_tr_b16 v[116:117], v39 offset:7168
    ds_read_b64_tr_b16 v[118:119], v39 offset:10752
    v_mfma_f32_16x16x32_bf16 v[220:223], v[84:87], a[68:71], v[220:223]
    v_add_f32 v114, v148, v149
    v_mfma_f32_16x16x32_bf16 v[196:199], v[88:91], a[64:67], v[196:199]
    ds_read_b64_tr_b16 v[120:121], v39 offset:7200
    ds_read_b64_tr_b16 v[122:123], v39 offset:10784
    v_mfma_f32_16x16x32_bf16 v[224:227], v[88:91], a[68:71], v[224:227]
    v_mov_b32 v112, v114
    v_mfma_f32_16x16x32_bf16 v[200:203], v[92:95], a[64:67], v[200:203]
    buffer_load_dwordx4 a[104:107], v11, s[36:39], s77 offen offset:1024 sc1
    ds_read_b64_tr_b16 v[124:125], v39 offset:7232
    ds_read_b64_tr_b16 v[126:127], v39 offset:10816
    v_mfma_f32_16x16x32_bf16 v[228:231], v[92:95], a[68:71], v[228:231]
    v_add_f32 v115, v156, v157
    v_mfma_f32_16x16x32_bf16 v[204:207], v[96:99], a[64:67], v[204:207]
    ds_read_b64_tr_b16 v[128:129], v39 offset:7264
    v_mfma_f32_16x16x32_bf16 v[232:235], v[96:99], a[68:71], v[232:235]
    ds_read_b64_tr_b16 v[130:131], v39 offset:10848
    v_mov_b32 v113, v115
    s_waitcnt lgkmcnt(8)
    v_mfma_f32_16x16x32_bf16 v[208:211], v[100:103], a[64:67], v[208:211]
    ds_read_b64_tr_b16 v[132:133], v39 offset:7296
    v_mfma_f32_16x16x32_bf16 v[236:239], v[100:103], a[68:71], v[236:239]
    buffer_load_dwordx4 a[108:111], v12, s[36:39], s77 offen offset:1024 sc1
    ds_read_b64_tr_b16 v[134:135], v39 offset:10880
    v_permlane16_swap_b32 v112, v114
    v_mfma_f32_16x16x32_bf16 v[212:215], v[104:107], a[64:67], v[212:215]
    ds_read_b64_tr_b16 v[136:137], v39 offset:7328
    v_mfma_f32_16x16x32_bf16 v[240:243], v[104:107], a[68:71], v[240:243]
    ds_read_b64_tr_b16 v[138:139], v39 offset:10912
    v_permlane16_swap_b32 v113, v115
    v_mfma_f32_16x16x32_bf16 v[216:219], v[108:111], a[64:67], v[216:219]
    ds_read_b64_tr_b16 v[140:141], v39 offset:7360
    v_mfma_f32_16x16x32_bf16 v[244:247], v[108:111], a[68:71], v[244:247]
    ds_read_b64_tr_b16 v[142:143], v39 offset:10944
    s_waitcnt vmcnt(8) lgkmcnt(6)
    v_mfma_f32_16x16x32_bf16 v[192:195], v[116:119], a[72:75], v[192:195]
    s_add_u32 s75, s75, 2048
    s_and_b32 s75, s75, 0x3fff
    s_add_u32 s77, s74, s75
    buffer_load_dwordx4 a[112:115], v11, s[36:39], s77 offen offset:0 sc1
    ds_read_b64_tr_b16 v[84:85], v39 offset:14336
    ds_read_b64_tr_b16 v[86:87], v39 offset:17920
    v_mfma_f32_16x16x32_bf16 v[220:223], v[116:119], a[76:79], v[220:223]
    s_mov_b32 s48, 0x3b000000
    v_mfma_f32_16x16x32_bf16 v[196:199], v[120:123], a[72:75], v[196:199]
    ds_read_b64_tr_b16 v[88:89], v39 offset:14368
    ds_read_b64_tr_b16 v[90:91], v39 offset:17952
    v_mfma_f32_16x16x32_bf16 v[224:227], v[120:123], a[76:79], v[224:227]
    v_mul_f32_e64 v144, v112, s48
    v_mfma_f32_16x16x32_bf16 v[200:203], v[124:127], a[72:75], v[200:203]
    ds_read_b64_tr_b16 v[92:93], v39 offset:14400
    ds_read_b64_tr_b16 v[94:95], v39 offset:17984
    v_mfma_f32_16x16x32_bf16 v[228:231], v[124:127], a[76:79], v[228:231]
    buffer_load_dwordx4 a[116:119], v12, s[36:39], s77 offen offset:0 sc1
    v_mul_f32_e64 v145, v113, s48
    v_mfma_f32_16x16x32_bf16 v[204:207], v[128:131], a[72:75], v[204:207]
    ds_read_b64_tr_b16 v[96:97], v39 offset:14432
    v_mfma_f32_16x16x32_bf16 v[232:235], v[128:131], a[76:79], v[232:235]
    ds_read_b64_tr_b16 v[98:99], v39 offset:18016
    v_mul_f32_e64 v146, v144, v144
    s_waitcnt lgkmcnt(8)
    v_mfma_f32_16x16x32_bf16 v[208:211], v[132:135], a[72:75], v[208:211]
    ds_read_b64_tr_b16 v[100:101], v39 offset:14464
    v_mfma_f32_16x16x32_bf16 v[236:239], v[132:135], a[76:79], v[236:239]
    ds_read_b64_tr_b16 v[102:103], v39 offset:18048
    v_mul_f32_e64 v147, v145, v145
    v_mfma_f32_16x16x32_bf16 v[212:215], v[136:139], a[72:75], v[212:215]
    buffer_load_dwordx4 a[120:123], v11, s[36:39], s77 offen offset:1024 sc1
    ds_read_b64_tr_b16 v[104:105], v39 offset:14496
    v_mfma_f32_16x16x32_bf16 v[240:243], v[136:139], a[76:79], v[240:243]
    ds_read_b64_tr_b16 v[106:107], v39 offset:18080
    v_fma_f32 v146, v114, s48, -v146
    v_mfma_f32_16x16x32_bf16 v[216:219], v[140:143], a[72:75], v[216:219]
    ds_read_b64_tr_b16 v[108:109], v39 offset:14528
    v_mfma_f32_16x16x32_bf16 v[244:247], v[140:143], a[76:79], v[244:247]
    ds_read_b64_tr_b16 v[110:111], v39 offset:18112
    s_waitcnt vmcnt(9) lgkmcnt(6)
    v_mfma_f32_16x16x32_bf16 v[192:195], v[84:87], a[80:83], v[192:195]
    ds_read_b64_tr_b16 v[116:117], v39 offset:21504
    ds_read_b64_tr_b16 v[118:119], v39 offset:25088
    v_mfma_f32_16x16x32_bf16 v[220:223], v[84:87], a[84:87], v[220:223]
    buffer_load_dwordx4 a[124:127], v12, s[36:39], s77 offen offset:1024 sc1
    v_fma_f32 v147, v115, s48, -v147
    v_mfma_f32_16x16x32_bf16 v[196:199], v[88:91], a[80:83], v[196:199]
    ds_read_b64_tr_b16 v[120:121], v39 offset:21536
    ds_read_b64_tr_b16 v[122:123], v39 offset:25120
    v_mfma_f32_16x16x32_bf16 v[224:227], v[88:91], a[84:87], v[224:227]
    v_max_f32 v146, 0, v146
    v_mfma_f32_16x16x32_bf16 v[200:203], v[92:95], a[80:83], v[200:203]
    ds_read_b64_tr_b16 v[124:125], v39 offset:21568
    ds_read_b64_tr_b16 v[126:127], v39 offset:25152
    v_mfma_f32_16x16x32_bf16 v[228:231], v[92:95], a[84:87], v[228:231]
    v_max_f32 v147, 0, v147
    v_mfma_f32_16x16x32_bf16 v[204:207], v[96:99], a[80:83], v[204:207]
    s_mul_i32 s73, s2, 7168
    s_lshl_b32 s46, s3, 11
    s_add_u32 s73, s73, s46
    buffer_load_dwordx4 v[52:55], v11, s[28:31], s73 offen
    ds_read_b64_tr_b16 v[128:129], v39 offset:21600
    v_mfma_f32_16x16x32_bf16 v[232:235], v[96:99], a[84:87], v[232:235]
    ds_read_b64_tr_b16 v[130:131], v39 offset:25184
    s_mov_b32 s48, 0x3727c5ac
    s_waitcnt lgkmcnt(8)
    v_mfma_f32_16x16x32_bf16 v[208:211], v[100:103], a[80:83], v[208:211]
    ds_read_b64_tr_b16 v[132:133], v39 offset:21632
    v_mfma_f32_16x16x32_bf16 v[236:239], v[100:103], a[84:87], v[236:239]
    ds_read_b64_tr_b16 v[134:135], v39 offset:25216
    v_cvt_pk_bf16_f32 v1, v144, v145
    v_mfma_f32_16x16x32_bf16 v[212:215], v[104:107], a[80:83], v[212:215]
    ds_read_b64_tr_b16 v[136:137], v39 offset:21664
    v_mfma_f32_16x16x32_bf16 v[240:243], v[104:107], a[84:87], v[240:243]
    buffer_load_dwordx4 v[52:55], v11, s[28:31], s73 offen offset:1024
    ds_read_b64_tr_b16 v[138:139], v39 offset:25248
    v_lshlrev_b32 v32, 16, v1
    v_mfma_f32_16x16x32_bf16 v[216:219], v[108:111], a[80:83], v[216:219]
    ds_read_b64_tr_b16 v[140:141], v39 offset:21696
    v_mfma_f32_16x16x32_bf16 v[244:247], v[108:111], a[84:87], v[244:247]
    ds_read_b64_tr_b16 v[142:143], v39 offset:25280
    s_waitcnt vmcnt(10) lgkmcnt(6)
    v_mfma_f32_16x16x32_bf16 v[192:195], v[116:119], a[88:91], v[192:195]
    ds_read_b64_tr_b16 v[84:85], v39 offset:28672
    ds_read_b64_tr_b16 v[86:87], v39 offset:32256
    v_mfma_f32_16x16x32_bf16 v[220:223], v[116:119], a[92:95], v[220:223]
    v_and_b32 v33, 0xffff0000, v1
    v_mfma_f32_16x16x32_bf16 v[196:199], v[120:123], a[88:91], v[196:199]
    ds_read_b64_tr_b16 v[88:89], v39 offset:28704
    ds_read_b64_tr_b16 v[90:91], v39 offset:32288
    v_mfma_f32_16x16x32_bf16 v[224:227], v[120:123], a[92:95], v[224:227]
    v_cvt_pk_bf16_f32 v2, v146, v147
    v_mfma_f32_16x16x32_bf16 v[200:203], v[124:127], a[88:91], v[200:203]
    ds_read_b64_tr_b16 v[92:93], v39 offset:28736
    ds_read_b64_tr_b16 v[94:95], v39 offset:32320
    v_mfma_f32_16x16x32_bf16 v[228:231], v[124:127], a[92:95], v[228:231]
    v_lshlrev_b32 v34, 16, v2
    v_mfma_f32_16x16x32_bf16 v[204:207], v[128:131], a[88:91], v[204:207]
    ds_read_b64_tr_b16 v[96:97], v39 offset:28768
    v_mfma_f32_16x16x32_bf16 v[232:235], v[128:131], a[92:95], v[232:235]
    ds_read_b64_tr_b16 v[98:99], v39 offset:32352
    v_and_b32 v35, 0xffff0000, v2
    s_waitcnt lgkmcnt(8)
    v_mfma_f32_16x16x32_bf16 v[208:211], v[132:135], a[88:91], v[208:211]
    ds_read_b64_tr_b16 v[100:101], v39 offset:28800
    v_mfma_f32_16x16x32_bf16 v[236:239], v[132:135], a[92:95], v[236:239]
    ds_read_b64_tr_b16 v[102:103], v39 offset:32384
    v_add_f32_e64 v34, v34, s48
    v_mfma_f32_16x16x32_bf16 v[212:215], v[136:139], a[88:91], v[212:215]
    ds_read_b64_tr_b16 v[104:105], v39 offset:28832
    v_mfma_f32_16x16x32_bf16 v[240:243], v[136:139], a[92:95], v[240:243]
    ds_read_b64_tr_b16 v[106:107], v39 offset:32416
    v_add_f32_e64 v35, v35, s48
    v_mfma_f32_16x16x32_bf16 v[216:219], v[140:143], a[88:91], v[216:219]
    ds_read_b64_tr_b16 v[108:109], v39 offset:28864
    v_mfma_f32_16x16x32_bf16 v[244:247], v[140:143], a[92:95], v[244:247]
    ds_read_b64_tr_b16 v[110:111], v39 offset:32448
    s_waitcnt vmcnt(8) lgkmcnt(6)
    v_mfma_f32_16x16x32_bf16 v[192:195], v[84:87], a[96:99], v[192:195]
    ds_read_b64_tr_b16 v[116:117], v39 offset:35840
    ds_read_b64_tr_b16 v[118:119], v39 offset:39424
    v_mfma_f32_16x16x32_bf16 v[220:223], v[84:87], a[100:103], v[220:223]
    v_cvt_pk_bf16_f32 v2, v34, v35
    v_mfma_f32_16x16x32_bf16 v[196:199], v[88:91], a[96:99], v[196:199]
    ds_read_b64_tr_b16 v[120:121], v39 offset:35872
    ds_read_b64_tr_b16 v[122:123], v39 offset:39456
    v_mfma_f32_16x16x32_bf16 v[224:227], v[88:91], a[100:103], v[224:227]
    v_lshlrev_b32 v34, 16, v2
    v_mfma_f32_16x16x32_bf16 v[200:203], v[92:95], a[96:99], v[200:203]
    ds_read_b64_tr_b16 v[124:125], v39 offset:35904
    v_mfma_f32_16x16x32_bf16 v[228:231], v[92:95], a[100:103], v[228:231]
    ds_read_b64_tr_b16 v[126:127], v39 offset:39488
    v_and_b32 v35, 0xffff0000, v2
    v_mfma_f32_16x16x32_bf16 v[204:207], v[96:99], a[96:99], v[204:207]
    ds_read_b64_tr_b16 v[128:129], v39 offset:35936
    v_mfma_f32_16x16x32_bf16 v[232:235], v[96:99], a[100:103], v[232:235]
    ds_read_b64_tr_b16 v[130:131], v39 offset:39520
    s_waitcnt lgkmcnt(8)
    v_mfma_f32_16x16x32_bf16 v[208:211], v[100:103], a[96:99], v[208:211]
    v_sqrt_f32 v34, v34
    ds_read_b64_tr_b16 v[132:133], v39 offset:35968
    v_mfma_f32_16x16x32_bf16 v[236:239], v[100:103], a[100:103], v[236:239]
    ds_read_b64_tr_b16 v[134:135], v39 offset:39552
    v_mfma_f32_16x16x32_bf16 v[212:215], v[104:107], a[96:99], v[212:215]
    v_sqrt_f32 v35, v35
    v_mfma_f32_16x16x32_bf16 v[240:243], v[104:107], a[100:103], v[240:243]
    ds_read_b64_tr_b16 v[136:137], v39 offset:36000
    ds_read_b64_tr_b16 v[138:139], v39 offset:39584
    v_mfma_f32_16x16x32_bf16 v[216:219], v[108:111], a[96:99], v[216:219]
    ds_read_b64_tr_b16 v[140:141], v39 offset:36032
    v_mfma_f32_16x16x32_bf16 v[244:247], v[108:111], a[100:103], v[244:247]
    ds_read_b64_tr_b16 v[142:143], v39 offset:39616
    s_waitcnt vmcnt(6) lgkmcnt(6)
    v_mfma_f32_16x16x32_bf16 v[192:195], v[116:119], a[104:107], v[192:195]
    ds_read_b64_tr_b16 v[84:85], v39 offset:43008
    ds_read_b64_tr_b16 v[86:87], v39 offset:46592
    v_mfma_f32_16x16x32_bf16 v[220:223], v[116:119], a[108:111], v[220:223]
    v_cvt_pk_bf16_f32 v2, v34, v35
    v_mfma_f32_16x16x32_bf16 v[196:199], v[120:123], a[104:107], v[196:199]
    ds_read_b64_tr_b16 v[88:89], v39 offset:43040
    ds_read_b64_tr_b16 v[90:91], v39 offset:46624
    v_mfma_f32_16x16x32_bf16 v[224:227], v[120:123], a[108:111], v[224:227]
    v_lshlrev_b32 v34, 16, v2
    v_mfma_f32_16x16x32_bf16 v[200:203], v[124:127], a[104:107], v[200:203]
    ds_read_b64_tr_b16 v[92:93], v39 offset:43072
    v_mfma_f32_16x16x32_bf16 v[228:231], v[124:127], a[108:111], v[228:231]
    ds_read_b64_tr_b16 v[94:95], v39 offset:46656
    v_and_b32 v35, 0xffff0000, v2
    v_mfma_f32_16x16x32_bf16 v[204:207], v[128:131], a[104:107], v[204:207]
    ds_read_b64_tr_b16 v[96:97], v39 offset:43104
    v_mfma_f32_16x16x32_bf16 v[232:235], v[128:131], a[108:111], v[232:235]
    ds_read_b64_tr_b16 v[98:99], v39 offset:46688
    s_waitcnt lgkmcnt(8)
    v_mfma_f32_16x16x32_bf16 v[208:211], v[132:135], a[104:107], v[208:211]
    v_rcp_f32 v36, v34
    ds_read_b64_tr_b16 v[100:101], v39 offset:43136
    v_mfma_f32_16x16x32_bf16 v[236:239], v[132:135], a[108:111], v[236:239]
    ds_read_b64_tr_b16 v[102:103], v39 offset:46720
    v_mfma_f32_16x16x32_bf16 v[212:215], v[136:139], a[104:107], v[212:215]
    v_rcp_f32 v37, v35
    v_mfma_f32_16x16x32_bf16 v[240:243], v[136:139], a[108:111], v[240:243]
    ds_read_b64_tr_b16 v[104:105], v39 offset:43168
    ds_read_b64_tr_b16 v[106:107], v39 offset:46752
    v_mfma_f32_16x16x32_bf16 v[216:219], v[140:143], a[104:107], v[216:219]
    ds_read_b64_tr_b16 v[108:109], v39 offset:43200
    v_mfma_f32_16x16x32_bf16 v[244:247], v[140:143], a[108:111], v[244:247]
    ds_read_b64_tr_b16 v[110:111], v39 offset:46784
    s_waitcnt vmcnt(4) lgkmcnt(6)
    v_mfma_f32_16x16x32_bf16 v[192:195], v[84:87], a[112:115], v[192:195]
    ds_read_b64_tr_b16 v[116:117], v39 offset:50176
    ds_read_b64_tr_b16 v[118:119], v39 offset:53760
    v_mfma_f32_16x16x32_bf16 v[220:223], v[84:87], a[116:119], v[220:223]
    s_mov_b32 s48, 0xc0135761
    v_mfma_f32_16x16x32_bf16 v[196:199], v[88:91], a[112:115], v[196:199]
    ds_read_b64_tr_b16 v[120:121], v39 offset:50208
    ds_read_b64_tr_b16 v[122:123], v39 offset:53792
    v_mfma_f32_16x16x32_bf16 v[224:227], v[88:91], a[116:119], v[224:227]
    s_mov_b32 s50, 0x3d372713
    v_mfma_f32_16x16x32_bf16 v[200:203], v[92:95], a[112:115], v[200:203]
    ds_read_b64_tr_b16 v[124:125], v39 offset:50240
    v_mfma_f32_16x16x32_bf16 v[228:231], v[92:95], a[116:119], v[228:231]
    ds_read_b64_tr_b16 v[126:127], v39 offset:53824
    v_mul_f32_e64 v50, v36, v36
    v_mfma_f32_16x16x32_bf16 v[204:207], v[96:99], a[112:115], v[204:207]
    ds_read_b64_tr_b16 v[128:129], v39 offset:50272
    v_mfma_f32_16x16x32_bf16 v[232:235], v[96:99], a[116:119], v[232:235]
    ds_read_b64_tr_b16 v[130:131], v39 offset:53856
    s_waitcnt lgkmcnt(8)
    v_mfma_f32_16x16x32_bf16 v[208:211], v[100:103], a[112:115], v[208:211]
    v_mul_f32_e64 v51, v37, v37
    ds_read_b64_tr_b16 v[132:133], v39 offset:50304
    v_mfma_f32_16x16x32_bf16 v[236:239], v[100:103], a[116:119], v[236:239]
    ds_read_b64_tr_b16 v[134:135], v39 offset:53888
    v_mfma_f32_16x16x32_bf16 v[212:215], v[104:107], a[112:115], v[212:215]
    v_mul_f32_e64 v36, v36, s48
    v_mfma_f32_16x16x32_bf16 v[240:243], v[104:107], a[116:119], v[240:243]
    ds_read_b64_tr_b16 v[136:137], v39 offset:50336
    ds_read_b64_tr_b16 v[138:139], v39 offset:53920
    v_mfma_f32_16x16x32_bf16 v[216:219], v[108:111], a[112:115], v[216:219]
    ds_read_b64_tr_b16 v[140:141], v39 offset:50368
    v_mfma_f32_16x16x32_bf16 v[244:247], v[108:111], a[116:119], v[244:247]
    ds_read_b64_tr_b16 v[142:143], v39 offset:53952
    s_waitcnt vmcnt(2) lgkmcnt(6)
    v_mfma_f32_16x16x32_bf16 v[192:195], v[116:119], a[120:123], v[192:195]
    v_mul_f32_e64 v37, v37, s48
    v_mfma_f32_16x16x32_bf16 v[220:223], v[116:119], a[124:127], v[220:223]
    v_mfma_f32_16x16x32_bf16 v[196:199], v[120:123], a[120:123], v[196:199]
    v_mul_f32_e64 v50, v50, s50
    v_mfma_f32_16x16x32_bf16 v[224:227], v[120:123], a[124:127], v[224:227]
    v_mfma_f32_16x16x32_bf16 v[200:203], v[124:127], a[120:123], v[200:203]
    v_mfma_f32_16x16x32_bf16 v[228:231], v[124:127], a[124:127], v[228:231]
    v_mul_f32_e64 v51, v51, s50
    v_mfma_f32_16x16x32_bf16 v[204:207], v[128:131], a[120:123], v[204:207]
    v_mfma_f32_16x16x32_bf16 v[232:235], v[128:131], a[124:127], v[232:235]
    s_waitcnt lgkmcnt(0)
    v_mfma_f32_16x16x32_bf16 v[208:211], v[132:135], a[120:123], v[208:211]
    v_mul_f32_e64 v50, v50, v36
    v_mfma_f32_16x16x32_bf16 v[236:239], v[132:135], a[124:127], v[236:239]
    v_mfma_f32_16x16x32_bf16 v[212:215], v[136:139], a[120:123], v[212:215]
    v_mfma_f32_16x16x32_bf16 v[240:243], v[136:139], a[124:127], v[240:243]
    v_mul_f32_e64 v51, v51, v37
    v_mfma_f32_16x16x32_bf16 v[216:219], v[140:143], a[120:123], v[216:219]
    v_mfma_f32_16x16x32_bf16 v[244:247], v[140:143], a[124:127], v[244:247]
    s_barrier
    s_lshl2_add_u32 s58, s66, s3
    s_lshl4_add_u32 s58, s58, s67
    s_mul_i32 s74, s58, 7168
    s_add_u32 s74, s74, 0x800000
    s_add_u32 s75, s74, 4096
    s_add_u32 m0, s80, 0
    s_lshl1_add_u32 s73, s86, 0
    s_and_b32 s73, s73, 7
    s_mul_i32 s73, s73, 114688
    s_add_u32 s73, s73, s81
    buffer_load_dwordx4 v19, s[28:31], s73 offen offset:0 lds
    v_pk_fma_f32 v[192:193], v[32:33], v[164:165], v[192:193] op_sel:[0,0,0] op_sel_hi:[0,1,1] neg_lo:[1,0,0] neg_hi:[1,0,0]
    v_pk_fma_f32 v[194:195], v[32:33], v[166:167], v[194:195] op_sel:[0,0,0] op_sel_hi:[0,1,1] neg_lo:[1,0,0] neg_hi:[1,0,0]
    v_pk_fma_f32 v[196:197], v[32:33], v[168:169], v[196:197] op_sel:[0,0,0] op_sel_hi:[0,1,1] neg_lo:[1,0,0] neg_hi:[1,0,0]
    v_pk_fma_f32 v[198:199], v[32:33], v[170:171], v[198:199] op_sel:[0,0,0] op_sel_hi:[0,1,1] neg_lo:[1,0,0] neg_hi:[1,0,0]
    v_pk_fma_f32 v[220:221], v[32:33], v[164:165], v[220:221] op_sel:[1,0,0] op_sel_hi:[1,1,1] neg_lo:[1,0,0] neg_hi:[1,0,0]
    v_pk_fma_f32 v[222:223], v[32:33], v[166:167], v[222:223] op_sel:[1,0,0] op_sel_hi:[1,1,1] neg_lo:[1,0,0] neg_hi:[1,0,0]
    v_pk_fma_f32 v[224:225], v[32:33], v[168:169], v[224:225] op_sel:[1,0,0] op_sel_hi:[1,1,1] neg_lo:[1,0,0] neg_hi:[1,0,0]
    v_pk_fma_f32 v[226:227], v[32:33], v[170:171], v[226:227] op_sel:[1,0,0] op_sel_hi:[1,1,1] neg_lo:[1,0,0] neg_hi:[1,0,0]
    v_pk_mul_f32 v[84:85], v[192:193], v[192:193] op_sel:[0,0] op_sel_hi:[1,1]
    v_pk_mul_f32 v[86:87], v[194:195], v[194:195] op_sel:[0,0] op_sel_hi:[1,1]
    v_pk_mul_f32 v[88:89], v[196:197], v[196:197] op_sel:[0,0] op_sel_hi:[1,1]
    v_pk_mul_f32 v[90:91], v[198:199], v[198:199] op_sel:[0,0] op_sel_hi:[1,1]
    v_pk_mul_f32 v[92:93], v[220:221], v[220:221] op_sel:[0,0] op_sel_hi:[1,1]
    v_pk_mul_f32 v[94:95], v[222:223], v[222:223] op_sel:[0,0] op_sel_hi:[1,1]
    v_pk_mul_f32 v[96:97], v[224:225], v[224:225] op_sel:[0,0] op_sel_hi:[1,1]
    v_pk_mul_f32 v[98:99], v[226:227], v[226:227] op_sel:[0,0] op_sel_hi:[1,1]
    v_pk_fma_f32 v[84:85], v[84:85], v[50:51], v[36:37] op_sel:[0,0,0] op_sel_hi:[1,0,0]
    v_pk_fma_f32 v[86:87], v[86:87], v[50:51], v[36:37] op_sel:[0,0,0] op_sel_hi:[1,0,0]
    v_pk_fma_f32 v[88:89], v[88:89], v[50:51], v[36:37] op_sel:[0,0,0] op_sel_hi:[1,0,0]
    v_pk_fma_f32 v[90:91], v[90:91], v[50:51], v[36:37] op_sel:[0,0,0] op_sel_hi:[1,0,0]
    v_pk_fma_f32 v[92:93], v[92:93], v[50:51], v[36:37] op_sel:[0,1,1] op_sel_hi:[1,1,1]
    v_pk_fma_f32 v[94:95], v[94:95], v[50:51], v[36:37] op_sel:[0,1,1] op_sel_hi:[1,1,1]
    v_pk_fma_f32 v[96:97], v[96:97], v[50:51], v[36:37] op_sel:[0,1,1] op_sel_hi:[1,1,1]
    v_pk_fma_f32 v[98:99], v[98:99], v[50:51], v[36:37] op_sel:[0,1,1] op_sel_hi:[1,1,1]
    v_pk_mul_f32 v[84:85], v[84:85], v[192:193] op_sel:[0,0] op_sel_hi:[1,1]
    v_pk_mul_f32 v[86:87], v[86:87], v[194:195] op_sel:[0,0] op_sel_hi:[1,1]
    v_pk_mul_f32 v[88:89], v[88:89], v[196:197] op_sel:[0,0] op_sel_hi:[1,1]
    v_pk_mul_f32 v[90:91], v[90:91], v[198:199] op_sel:[0,0] op_sel_hi:[1,1]
    v_pk_mul_f32 v[92:93], v[92:93], v[220:221] op_sel:[0,0] op_sel_hi:[1,1]
    v_pk_mul_f32 v[94:95], v[94:95], v[222:223] op_sel:[0,0] op_sel_hi:[1,1]
    buffer_load_dwordx4 v20, s[28:31], s73 offen offset:1024 lds
    v_pk_mul_f32 v[96:97], v[96:97], v[224:225] op_sel:[0,0] op_sel_hi:[1,1]
    v_pk_mul_f32 v[98:99], v[98:99], v[226:227] op_sel:[0,0] op_sel_hi:[1,1]
    v_exp_f32 v84, v84
    v_exp_f32 v85, v85
    v_exp_f32 v86, v86
    v_exp_f32 v87, v87
    v_exp_f32 v88, v88
    v_exp_f32 v89, v89
    v_exp_f32 v90, v90
    v_exp_f32 v91, v91
    v_exp_f32 v92, v92
    v_exp_f32 v93, v93
    v_exp_f32 v94, v94
    v_exp_f32 v95, v95
    v_exp_f32 v96, v96
    v_exp_f32 v97, v97
    v_exp_f32 v98, v98
    v_exp_f32 v99, v99
    v_pk_fma_f32 v[84:85], v[84:85], v[34:35], v[34:35] op_sel:[0,0,0] op_sel_hi:[1,0,0]
    v_pk_fma_f32 v[86:87], v[86:87], v[34:35], v[34:35] op_sel:[0,0,0] op_sel_hi:[1,0,0]
    v_pk_fma_f32 v[88:89], v[88:89], v[34:35], v[34:35] op_sel:[0,0,0] op_sel_hi:[1,0,0]
    buffer_load_dwordx4 v21, s[28:31], s73 offen offset:2048 lds
    v_pk_fma_f32 v[90:91], v[90:91], v[34:35], v[34:35] op_sel:[0,0,0] op_sel_hi:[1,0,0]
    v_pk_fma_f32 v[92:93], v[92:93], v[34:35], v[34:35] op_sel:[0,1,1] op_sel_hi:[1,1,1]
    v_pk_fma_f32 v[94:95], v[94:95], v[34:35], v[34:35] op_sel:[0,1,1] op_sel_hi:[1,1,1]
    v_pk_fma_f32 v[96:97], v[96:97], v[34:35], v[34:35] op_sel:[0,1,1] op_sel_hi:[1,1,1]
    v_pk_fma_f32 v[98:99], v[98:99], v[34:35], v[34:35] op_sel:[0,1,1] op_sel_hi:[1,1,1]
    v_rcp_f32 v84, v84
    v_rcp_f32 v85, v85
    v_rcp_f32 v86, v86
    v_rcp_f32 v87, v87
    v_rcp_f32 v88, v88
    v_rcp_f32 v89, v89
    v_rcp_f32 v90, v90
    v_rcp_f32 v91, v91
    v_rcp_f32 v92, v92
    v_rcp_f32 v93, v93
    v_rcp_f32 v94, v94
    v_rcp_f32 v95, v95
    v_rcp_f32 v96, v96
    v_rcp_f32 v97, v97
    v_rcp_f32 v98, v98
    v_rcp_f32 v99, v99
    buffer_load_dwordx4 v22, s[28:31], s73 offen offset:3072 lds
    v_pk_mul_f32 v[84:85], v[84:85], v[192:193] op_sel:[0,0] op_sel_hi:[1,1]
    v_pk_mul_f32 v[86:87], v[86:87], v[194:195] op_sel:[0,0] op_sel_hi:[1,1]
    v_pk_mul_f32 v[88:89], v[88:89], v[196:197] op_sel:[0,0] op_sel_hi:[1,1]
    v_pk_mul_f32 v[90:91], v[90:91], v[198:199] op_sel:[0,0] op_sel_hi:[1,1]
    v_pk_mul_f32 v[92:93], v[92:93], v[220:221] op_sel:[0,0] op_sel_hi:[1,1]
    v_pk_mul_f32 v[94:95], v[94:95], v[222:223] op_sel:[0,0] op_sel_hi:[1,1]
    v_pk_mul_f32 v[96:97], v[96:97], v[224:225] op_sel:[0,0] op_sel_hi:[1,1]
    v_pk_mul_f32 v[98:99], v[98:99], v[226:227] op_sel:[0,0] op_sel_hi:[1,1]
    v_cvt_pk_bf16_f32 v116, v84, v85
    v_cvt_pk_bf16_f32 v117, v86, v87
    v_cvt_pk_bf16_f32 v118, v88, v89
    v_cvt_pk_bf16_f32 v119, v90, v91
    v_cvt_pk_bf16_f32 v120, v92, v93
    v_cvt_pk_bf16_f32 v121, v94, v95
    v_cvt_pk_bf16_f32 v122, v96, v97
    v_cvt_pk_bf16_f32 v123, v98, v99
    buffer_store_dwordx4 v[116:119], v11, s[36:39], s74 offen offset:0 sc1
    buffer_store_dwordx4 v[120:123], v11, s[36:39], s74 offen offset:1024 sc1
    v_pk_fma_f32 v[200:201], v[32:33], v[172:173], v[200:201] op_sel:[0,0,0] op_sel_hi:[0,1,1] neg_lo:[1,0,0] neg_hi:[1,0,0]
    v_pk_fma_f32 v[202:203], v[32:33], v[174:175], v[202:203] op_sel:[0,0,0] op_sel_hi:[0,1,1] neg_lo:[1,0,0] neg_hi:[1,0,0]
    v_pk_fma_f32 v[204:205], v[32:33], v[176:177], v[204:205] op_sel:[0,0,0] op_sel_hi:[0,1,1] neg_lo:[1,0,0] neg_hi:[1,0,0]
    v_pk_fma_f32 v[206:207], v[32:33], v[178:179], v[206:207] op_sel:[0,0,0] op_sel_hi:[0,1,1] neg_lo:[1,0,0] neg_hi:[1,0,0]
    v_pk_fma_f32 v[228:229], v[32:33], v[172:173], v[228:229] op_sel:[1,0,0] op_sel_hi:[1,1,1] neg_lo:[1,0,0] neg_hi:[1,0,0]
    v_pk_fma_f32 v[230:231], v[32:33], v[174:175], v[230:231] op_sel:[1,0,0] op_sel_hi:[1,1,1] neg_lo:[1,0,0] neg_hi:[1,0,0]
    v_pk_fma_f32 v[232:233], v[32:33], v[176:177], v[232:233] op_sel:[1,0,0] op_sel_hi:[1,1,1] neg_lo:[1,0,0] neg_hi:[1,0,0]
    v_pk_fma_f32 v[234:235], v[32:33], v[178:179], v[234:235] op_sel:[1,0,0] op_sel_hi:[1,1,1] neg_lo:[1,0,0] neg_hi:[1,0,0]
    v_pk_mul_f32 v[84:85], v[200:201], v[200:201] op_sel:[0,0] op_sel_hi:[1,1]
    v_pk_mul_f32 v[86:87], v[202:203], v[202:203] op_sel:[0,0] op_sel_hi:[1,1]
    v_pk_mul_f32 v[88:89], v[204:205], v[204:205] op_sel:[0,0] op_sel_hi:[1,1]
    v_pk_mul_f32 v[90:91], v[206:207], v[206:207] op_sel:[0,0] op_sel_hi:[1,1]
    v_pk_mul_f32 v[92:93], v[228:229], v[228:229] op_sel:[0,0] op_sel_hi:[1,1]
    v_pk_mul_f32 v[94:95], v[230:231], v[230:231] op_sel:[0,0] op_sel_hi:[1,1]
    v_pk_mul_f32 v[96:97], v[232:233], v[232:233] op_sel:[0,0] op_sel_hi:[1,1]
    v_pk_mul_f32 v[98:99], v[234:235], v[234:235] op_sel:[0,0] op_sel_hi:[1,1]
    v_pk_fma_f32 v[84:85], v[84:85], v[50:51], v[36:37] op_sel:[0,0,0] op_sel_hi:[1,0,0]
    v_pk_fma_f32 v[86:87], v[86:87], v[50:51], v[36:37] op_sel:[0,0,0] op_sel_hi:[1,0,0]
    v_pk_fma_f32 v[88:89], v[88:89], v[50:51], v[36:37] op_sel:[0,0,0] op_sel_hi:[1,0,0]
    v_pk_fma_f32 v[90:91], v[90:91], v[50:51], v[36:37] op_sel:[0,0,0] op_sel_hi:[1,0,0]
    v_pk_fma_f32 v[92:93], v[92:93], v[50:51], v[36:37] op_sel:[0,1,1] op_sel_hi:[1,1,1]
    v_pk_fma_f32 v[94:95], v[94:95], v[50:51], v[36:37] op_sel:[0,1,1] op_sel_hi:[1,1,1]
    v_pk_fma_f32 v[96:97], v[96:97], v[50:51], v[36:37] op_sel:[0,1,1] op_sel_hi:[1,1,1]
    v_pk_fma_f32 v[98:99], v[98:99], v[50:51], v[36:37] op_sel:[0,1,1] op_sel_hi:[1,1,1]
    v_pk_mul_f32 v[84:85], v[84:85], v[200:201] op_sel:[0,0] op_sel_hi:[1,1]
    v_pk_mul_f32 v[86:87], v[86:87], v[202:203] op_sel:[0,0] op_sel_hi:[1,1]
    v_pk_mul_f32 v[88:89], v[88:89], v[204:205] op_sel:[0,0] op_sel_hi:[1,1]
    v_pk_mul_f32 v[90:91], v[90:91], v[206:207] op_sel:[0,0] op_sel_hi:[1,1]
    v_pk_mul_f32 v[92:93], v[92:93], v[228:229] op_sel:[0,0] op_sel_hi:[1,1]
    v_pk_mul_f32 v[94:95], v[94:95], v[230:231] op_sel:[0,0] op_sel_hi:[1,1]
    v_pk_mul_f32 v[96:97], v[96:97], v[232:233] op_sel:[0,0] op_sel_hi:[1,1]
    v_pk_mul_f32 v[98:99], v[98:99], v[234:235] op_sel:[0,0] op_sel_hi:[1,1]
    v_exp_f32 v84, v84
    v_exp_f32 v85, v85
    v_exp_f32 v86, v86
    v_exp_f32 v87, v87
    v_exp_f32 v88, v88
    s_add_u32 m0, s80, 4096
    s_add_u32 s73, s73, 32768
    buffer_load_dwordx4 v19, s[28:31], s73 offen offset:0 lds
    v_exp_f32 v89, v89
    v_exp_f32 v90, v90
    v_exp_f32 v91, v91
    v_exp_f32 v92, v92
    v_exp_f32 v93, v93
    v_exp_f32 v94, v94
    v_exp_f32 v95, v95
    v_exp_f32 v96, v96
    v_exp_f32 v97, v97
    v_exp_f32 v98, v98
    v_exp_f32 v99, v99
    v_pk_fma_f32 v[84:85], v[84:85], v[34:35], v[34:35] op_sel:[0,0,0] op_sel_hi:[1,0,0]
    v_pk_fma_f32 v[86:87], v[86:87], v[34:35], v[34:35] op_sel:[0,0,0] op_sel_hi:[1,0,0]
    v_pk_fma_f32 v[88:89], v[88:89], v[34:35], v[34:35] op_sel:[0,0,0] op_sel_hi:[1,0,0]
    v_pk_fma_f32 v[90:91], v[90:91], v[34:35], v[34:35] op_sel:[0,0,0] op_sel_hi:[1,0,0]
    v_pk_fma_f32 v[92:93], v[92:93], v[34:35], v[34:35] op_sel:[0,1,1] op_sel_hi:[1,1,1]
    v_pk_fma_f32 v[94:95], v[94:95], v[34:35], v[34:35] op_sel:[0,1,1] op_sel_hi:[1,1,1]
    v_pk_fma_f32 v[96:97], v[96:97], v[34:35], v[34:35] op_sel:[0,1,1] op_sel_hi:[1,1,1]
    v_pk_fma_f32 v[98:99], v[98:99], v[34:35], v[34:35] op_sel:[0,1,1] op_sel_hi:[1,1,1]
    v_rcp_f32 v84, v84
    v_rcp_f32 v85, v85
    v_rcp_f32 v86, v86
    buffer_load_dwordx4 v20, s[28:31], s73 offen offset:1024 lds
    v_rcp_f32 v87, v87
    v_rcp_f32 v88, v88
    v_rcp_f32 v89, v89
    v_rcp_f32 v90, v90
    v_rcp_f32 v91, v91
    v_rcp_f32 v92, v92
    v_rcp_f32 v93, v93
    v_rcp_f32 v94, v94
    v_rcp_f32 v95, v95
    v_rcp_f32 v96, v96
    v_rcp_f32 v97, v97
    v_rcp_f32 v98, v98
    v_rcp_f32 v99, v99
    v_pk_mul_f32 v[84:85], v[84:85], v[200:201] op_sel:[0,0] op_sel_hi:[1,1]
    v_pk_mul_f32 v[86:87], v[86:87], v[202:203] op_sel:[0,0] op_sel_hi:[1,1]
    v_pk_mul_f32 v[88:89], v[88:89], v[204:205] op_sel:[0,0] op_sel_hi:[1,1]
    v_pk_mul_f32 v[90:91], v[90:91], v[206:207] op_sel:[0,0] op_sel_hi:[1,1]
    v_pk_mul_f32 v[92:93], v[92:93], v[228:229] op_sel:[0,0] op_sel_hi:[1,1]
    v_pk_mul_f32 v[94:95], v[94:95], v[230:231] op_sel:[0,0] op_sel_hi:[1,1]
    v_pk_mul_f32 v[96:97], v[96:97], v[232:233] op_sel:[0,0] op_sel_hi:[1,1]
    v_pk_mul_f32 v[98:99], v[98:99], v[234:235] op_sel:[0,0] op_sel_hi:[1,1]
    v_cvt_pk_bf16_f32 v124, v84, v85
    v_cvt_pk_bf16_f32 v125, v86, v87
    buffer_load_dwordx4 v21, s[28:31], s73 offen offset:2048 lds
    v_cvt_pk_bf16_f32 v126, v88, v89
    v_cvt_pk_bf16_f32 v127, v90, v91
    v_cvt_pk_bf16_f32 v128, v92, v93
    v_cvt_pk_bf16_f32 v129, v94, v95
    v_cvt_pk_bf16_f32 v130, v96, v97
    v_cvt_pk_bf16_f32 v131, v98, v99
    buffer_store_dwordx4 v[124:127], v11, s[36:39], s74 offen offset:2048 sc1
    buffer_store_dwordx4 v[128:131], v11, s[36:39], s74 offen offset:3072 sc1
    v_pk_fma_f32 v[208:209], v[32:33], v[180:181], v[208:209] op_sel:[0,0,0] op_sel_hi:[0,1,1] neg_lo:[1,0,0] neg_hi:[1,0,0]
    v_pk_fma_f32 v[210:211], v[32:33], v[182:183], v[210:211] op_sel:[0,0,0] op_sel_hi:[0,1,1] neg_lo:[1,0,0] neg_hi:[1,0,0]
    v_pk_fma_f32 v[212:213], v[32:33], v[184:185], v[212:213] op_sel:[0,0,0] op_sel_hi:[0,1,1] neg_lo:[1,0,0] neg_hi:[1,0,0]
    v_pk_fma_f32 v[214:215], v[32:33], v[186:187], v[214:215] op_sel:[0,0,0] op_sel_hi:[0,1,1] neg_lo:[1,0,0] neg_hi:[1,0,0]
    v_pk_fma_f32 v[236:237], v[32:33], v[180:181], v[236:237] op_sel:[1,0,0] op_sel_hi:[1,1,1] neg_lo:[1,0,0] neg_hi:[1,0,0]
    v_pk_fma_f32 v[238:239], v[32:33], v[182:183], v[238:239] op_sel:[1,0,0] op_sel_hi:[1,1,1] neg_lo:[1,0,0] neg_hi:[1,0,0]
    v_pk_fma_f32 v[240:241], v[32:33], v[184:185], v[240:241] op_sel:[1,0,0] op_sel_hi:[1,1,1] neg_lo:[1,0,0] neg_hi:[1,0,0]
    v_pk_fma_f32 v[242:243], v[32:33], v[186:187], v[242:243] op_sel:[1,0,0] op_sel_hi:[1,1,1] neg_lo:[1,0,0] neg_hi:[1,0,0]
    v_pk_mul_f32 v[84:85], v[208:209], v[208:209] op_sel:[0,0] op_sel_hi:[1,1]
    v_pk_mul_f32 v[86:87], v[210:211], v[210:211] op_sel:[0,0] op_sel_hi:[1,1]
    v_pk_mul_f32 v[88:89], v[212:213], v[212:213] op_sel:[0,0] op_sel_hi:[1,1]
    v_pk_mul_f32 v[90:91], v[214:215], v[214:215] op_sel:[0,0] op_sel_hi:[1,1]
    v_pk_mul_f32 v[92:93], v[236:237], v[236:237] op_sel:[0,0] op_sel_hi:[1,1]
    v_pk_mul_f32 v[94:95], v[238:239], v[238:239] op_sel:[0,0] op_sel_hi:[1,1]
    v_pk_mul_f32 v[96:97], v[240:241], v[240:241] op_sel:[0,0] op_sel_hi:[1,1]
    v_pk_mul_f32 v[98:99], v[242:243], v[242:243] op_sel:[0,0] op_sel_hi:[1,1]
    v_pk_fma_f32 v[84:85], v[84:85], v[50:51], v[36:37] op_sel:[0,0,0] op_sel_hi:[1,0,0]
    v_pk_fma_f32 v[86:87], v[86:87], v[50:51], v[36:37] op_sel:[0,0,0] op_sel_hi:[1,0,0]
    v_pk_fma_f32 v[88:89], v[88:89], v[50:51], v[36:37] op_sel:[0,0,0] op_sel_hi:[1,0,0]
    v_pk_fma_f32 v[90:91], v[90:91], v[50:51], v[36:37] op_sel:[0,0,0] op_sel_hi:[1,0,0]
    v_pk_fma_f32 v[92:93], v[92:93], v[50:51], v[36:37] op_sel:[0,1,1] op_sel_hi:[1,1,1]
    v_pk_fma_f32 v[94:95], v[94:95], v[50:51], v[36:37] op_sel:[0,1,1] op_sel_hi:[1,1,1]
    v_pk_fma_f32 v[96:97], v[96:97], v[50:51], v[36:37] op_sel:[0,1,1] op_sel_hi:[1,1,1]
    v_pk_fma_f32 v[98:99], v[98:99], v[50:51], v[36:37] op_sel:[0,1,1] op_sel_hi:[1,1,1]
    v_pk_mul_f32 v[84:85], v[84:85], v[208:209] op_sel:[0,0] op_sel_hi:[1,1]
    v_pk_mul_f32 v[86:87], v[86:87], v[210:211] op_sel:[0,0] op_sel_hi:[1,1]
    v_pk_mul_f32 v[88:89], v[88:89], v[212:213] op_sel:[0,0] op_sel_hi:[1,1]
    v_pk_mul_f32 v[90:91], v[90:91], v[214:215] op_sel:[0,0] op_sel_hi:[1,1]
    v_pk_mul_f32 v[92:93], v[92:93], v[236:237] op_sel:[0,0] op_sel_hi:[1,1]
    v_pk_mul_f32 v[94:95], v[94:95], v[238:239] op_sel:[0,0] op_sel_hi:[1,1]
    v_pk_mul_f32 v[96:97], v[96:97], v[240:241] op_sel:[0,0] op_sel_hi:[1,1]
    v_pk_mul_f32 v[98:99], v[98:99], v[242:243] op_sel:[0,0] op_sel_hi:[1,1]
    v_exp_f32 v84, v84
    v_exp_f32 v85, v85
    v_exp_f32 v86, v86
    v_exp_f32 v87, v87
    v_exp_f32 v88, v88
    v_exp_f32 v89, v89
    v_exp_f32 v90, v90
    v_exp_f32 v91, v91
    v_exp_f32 v92, v92
    v_exp_f32 v93, v93
    v_exp_f32 v94, v94
    s_add_u32 m0, s80, 28672
    s_lshl1_add_u32 s73, s86, 1
    s_and_b32 s73, s73, 7
    s_mul_i32 s73, s73, 114688
    s_add_u32 s73, s73, s81
    buffer_load_dwordx4 v19, s[28:31], s73 offen offset:0 lds
    v_exp_f32 v95, v95
    v_exp_f32 v96, v96
    v_exp_f32 v97, v97
    v_exp_f32 v98, v98
    v_exp_f32 v99, v99
    v_pk_fma_f32 v[84:85], v[84:85], v[34:35], v[34:35] op_sel:[0,0,0] op_sel_hi:[1,0,0]
    v_pk_fma_f32 v[86:87], v[86:87], v[34:35], v[34:35] op_sel:[0,0,0] op_sel_hi:[1,0,0]
    v_pk_fma_f32 v[88:89], v[88:89], v[34:35], v[34:35] op_sel:[0,0,0] op_sel_hi:[1,0,0]
    v_pk_fma_f32 v[90:91], v[90:91], v[34:35], v[34:35] op_sel:[0,0,0] op_sel_hi:[1,0,0]
    v_pk_fma_f32 v[92:93], v[92:93], v[34:35], v[34:35] op_sel:[0,1,1] op_sel_hi:[1,1,1]
    v_pk_fma_f32 v[94:95], v[94:95], v[34:35], v[34:35] op_sel:[0,1,1] op_sel_hi:[1,1,1]
    v_pk_fma_f32 v[96:97], v[96:97], v[34:35], v[34:35] op_sel:[0,1,1] op_sel_hi:[1,1,1]
    v_pk_fma_f32 v[98:99], v[98:99], v[34:35], v[34:35] op_sel:[0,1,1] op_sel_hi:[1,1,1]
    v_rcp_f32 v84, v84
    v_rcp_f32 v85, v85
    v_rcp_f32 v86, v86
    v_rcp_f32 v87, v87
    v_rcp_f32 v88, v88
    v_rcp_f32 v89, v89
    v_rcp_f32 v90, v90
    v_rcp_f32 v91, v91
    v_rcp_f32 v92, v92
    buffer_load_dwordx4 v20, s[28:31], s73 offen offset:1024 lds
    v_rcp_f32 v93, v93
    v_rcp_f32 v94, v94
    v_rcp_f32 v95, v95
    v_rcp_f32 v96, v96
    v_rcp_f32 v97, v97
    v_rcp_f32 v98, v98
    v_rcp_f32 v99, v99
    v_pk_mul_f32 v[84:85], v[84:85], v[208:209] op_sel:[0,0] op_sel_hi:[1,1]
    v_pk_mul_f32 v[86:87], v[86:87], v[210:211] op_sel:[0,0] op_sel_hi:[1,1]
    v_pk_mul_f32 v[88:89], v[88:89], v[212:213] op_sel:[0,0] op_sel_hi:[1,1]
    v_pk_mul_f32 v[90:91], v[90:91], v[214:215] op_sel:[0,0] op_sel_hi:[1,1]
    v_pk_mul_f32 v[92:93], v[92:93], v[236:237] op_sel:[0,0] op_sel_hi:[1,1]
    v_pk_mul_f32 v[94:95], v[94:95], v[238:239] op_sel:[0,0] op_sel_hi:[1,1]
    v_pk_mul_f32 v[96:97], v[96:97], v[240:241] op_sel:[0,0] op_sel_hi:[1,1]
    v_pk_mul_f32 v[98:99], v[98:99], v[242:243] op_sel:[0,0] op_sel_hi:[1,1]
    v_cvt_pk_bf16_f32 v132, v84, v85
    v_cvt_pk_bf16_f32 v133, v86, v87
    v_cvt_pk_bf16_f32 v134, v88, v89
    v_cvt_pk_bf16_f32 v135, v90, v91
    v_cvt_pk_bf16_f32 v136, v92, v93
    v_cvt_pk_bf16_f32 v137, v94, v95
    v_cvt_pk_bf16_f32 v138, v96, v97
    v_cvt_pk_bf16_f32 v139, v98, v99
    buffer_store_dwordx4 v[132:135], v11, s[36:39], s75 offen offset:0 sc1
    buffer_store_dwordx4 v[136:139], v11, s[36:39], s75 offen offset:1024 sc1
    v_pk_fma_f32 v[216:217], v[32:33], v[188:189], v[216:217] op_sel:[0,0,0] op_sel_hi:[0,1,1] neg_lo:[1,0,0] neg_hi:[1,0,0]
    v_pk_fma_f32 v[218:219], v[32:33], v[190:191], v[218:219] op_sel:[0,0,0] op_sel_hi:[0,1,1] neg_lo:[1,0,0] neg_hi:[1,0,0]
    v_pk_fma_f32 v[244:245], v[32:33], v[188:189], v[244:245] op_sel:[1,0,0] op_sel_hi:[1,1,1] neg_lo:[1,0,0] neg_hi:[1,0,0]
    v_pk_fma_f32 v[246:247], v[32:33], v[190:191], v[246:247] op_sel:[1,0,0] op_sel_hi:[1,1,1] neg_lo:[1,0,0] neg_hi:[1,0,0]
    v_pk_mul_f32 v[84:85], v[216:217], v[216:217] op_sel:[0,0] op_sel_hi:[1,1]
    v_pk_mul_f32 v[86:87], v[218:219], v[218:219] op_sel:[0,0] op_sel_hi:[1,1]
    v_pk_mul_f32 v[88:89], v[244:245], v[244:245] op_sel:[0,0] op_sel_hi:[1,1]
    v_pk_mul_f32 v[90:91], v[246:247], v[246:247] op_sel:[0,0] op_sel_hi:[1,1]
    v_pk_fma_f32 v[84:85], v[84:85], v[50:51], v[36:37] op_sel:[0,0,0] op_sel_hi:[1,0,0]
    v_pk_fma_f32 v[86:87], v[86:87], v[50:51], v[36:37] op_sel:[0,0,0] op_sel_hi:[1,0,0]
    v_pk_fma_f32 v[88:89], v[88:89], v[50:51], v[36:37] op_sel:[0,1,1] op_sel_hi:[1,1,1]
    v_pk_fma_f32 v[90:91], v[90:91], v[50:51], v[36:37] op_sel:[0,1,1] op_sel_hi:[1,1,1]
    v_pk_mul_f32 v[84:85], v[84:85], v[216:217] op_sel:[0,0] op_sel_hi:[1,1]
    v_pk_mul_f32 v[86:87], v[86:87], v[218:219] op_sel:[0,0] op_sel_hi:[1,1]
    v_pk_mul_f32 v[88:89], v[88:89], v[244:245] op_sel:[0,0] op_sel_hi:[1,1]
    v_pk_mul_f32 v[90:91], v[90:91], v[246:247] op_sel:[0,0] op_sel_hi:[1,1]
    v_exp_f32 v84, v84
    v_exp_f32 v85, v85
    v_exp_f32 v86, v86
    v_exp_f32 v87, v87
    v_exp_f32 v88, v88
    v_exp_f32 v89, v89
    v_exp_f32 v90, v90
    v_exp_f32 v91, v91
    buffer_load_dwordx4 v21, s[28:31], s73 offen offset:2048 lds
    v_pk_fma_f32 v[84:85], v[84:85], v[34:35], v[34:35] op_sel:[0,0,0] op_sel_hi:[1,0,0]
    v_pk_fma_f32 v[86:87], v[86:87], v[34:35], v[34:35] op_sel:[0,0,0] op_sel_hi:[1,0,0]
    v_pk_fma_f32 v[88:89], v[88:89], v[34:35], v[34:35] op_sel:[0,1,1] op_sel_hi:[1,1,1]
    v_pk_fma_f32 v[90:91], v[90:91], v[34:35], v[34:35] op_sel:[0,1,1] op_sel_hi:[1,1,1]
    v_rcp_f32 v84, v84
    v_rcp_f32 v85, v85
    v_rcp_f32 v86, v86
    v_rcp_f32 v87, v87
    v_rcp_f32 v88, v88
    v_rcp_f32 v89, v89
    v_rcp_f32 v90, v90
    v_rcp_f32 v91, v91
    v_pk_mul_f32 v[84:85], v[84:85], v[216:217] op_sel:[0,0] op_sel_hi:[1,1]
    v_pk_mul_f32 v[86:87], v[86:87], v[218:219] op_sel:[0,0] op_sel_hi:[1,1]
    v_pk_mul_f32 v[88:89], v[88:89], v[244:245] op_sel:[0,0] op_sel_hi:[1,1]
    v_pk_mul_f32 v[90:91], v[90:91], v[246:247] op_sel:[0,0] op_sel_hi:[1,1]
    v_cvt_pk_bf16_f32 v140, v84, v85
    v_cvt_pk_bf16_f32 v141, v86, v87
    v_cvt_pk_bf16_f32 v142, v88, v89
    v_cvt_pk_bf16_f32 v143, v90, v91
    buffer_store_dwordx4 v[140:143], v11, s[36:39], s75 offen offset:2048 sc1
    ds_read_b128 v[180:183], v16 offset:3776
    ds_read_b128 v[184:187], v16 offset:3264
    ds_read_b128 v[188:191], v16 offset:2752
    ds_read_b128 v[192:195], v16 offset:2240
    ds_read_b128 v[196:199], v16 offset:1728
    ds_read_b128 v[200:203], v16 offset:1216
    ds_read_b128 v[204:207], v16 offset:704
    ds_read_b128 v[208:211], v16 offset:192
    ds_read2_b32 v[148:149], v27 offset0:48 offset1:49
    ds_read2_b32 v[150:151], v27 offset0:50 offset1:51
    ds_read2_b32 v[152:153], v27 offset0:176 offset1:177
    ds_read2_b32 v[154:155], v27 offset0:178 offset1:179
    ds_read2_b32 v[156:157], v28 offset0:48 offset1:49
    ds_read2_b32 v[158:159], v28 offset0:50 offset1:51
    ds_read2_b32 v[160:161], v28 offset0:176 offset1:177
    ds_read2_b32 v[162:163], v28 offset0:178 offset1:179
    ds_read2_b32 v[164:165], v29 offset0:48 offset1:49
    ds_read2_b32 v[166:167], v29 offset0:50 offset1:51
    ds_read2_b32 v[168:169], v29 offset0:176 offset1:177
    ds_read2_b32 v[170:171], v29 offset0:178 offset1:179
    ds_read2_b32 v[172:173], v30 offset0:48 offset1:49
    ds_read2_b32 v[174:175], v30 offset0:50 offset1:51
    ds_read2_b32 v[176:177], v30 offset0:176 offset1:177
    buffer_load_dwordx4 v22, s[28:31], s73 offen offset:3072 lds
    ds_read2_b32 v[178:179], v30 offset0:178 offset1:179
    ds_read_b64 v[32:33], v17 offset:1536
    ds_read_b64 v[34:35], v17 offset:1024
    ds_read_b64 v[36:37], v17 offset:512
    ds_read_b64 v[38:39], v17 offset:0
    s_lshl4_add_u32 s59, s66, s67
    s_lshr_b32 s58, s59, 2
    s_lshl_b32 s58, s58, 8
    s_and_b32 s83, s59, 3
    s_lshl2_add_u32 s83, s83, s58
    s_add_u32 s83, s83, 0xf4c000
    s_waitcnt lgkmcnt(15)
    v_mfma_f32_16x16x32_bf16 a[192:195], v[148:151], v[180:183], a[192:195]
    v_mfma_f32_16x16x32_bf16 a[196:199], v[148:151], v[184:187], a[196:199]
    v_mfma_f32_16x16x32_bf16 a[200:203], v[148:151], v[188:191], a[200:203]
    v_mfma_f32_16x16x32_bf16 a[204:207], v[148:151], v[192:195], a[204:207]
    v_mfma_f32_16x16x32_bf16 a[208:211], v[148:151], v[196:199], a[208:211]
    v_mfma_f32_16x16x32_bf16 a[212:215], v[148:151], v[200:203], a[212:215]
    v_mfma_f32_16x16x32_bf16 a[216:219], v[148:151], v[204:207], a[216:219]
    s_add_u32 m0, s80, 32768
    s_add_u32 s73, s73, 32768
    buffer_load_dwordx4 v19, s[28:31], s73 offen offset:0 lds
    v_mfma_f32_16x16x32_bf16 a[220:223], v[148:151], v[208:211], a[220:223]
    s_waitcnt lgkmcnt(15)
    v_mfma_f32_16x16x32_bf16 a[196:199], v[152:155], v[180:183], a[196:199]
    v_mfma_f32_16x16x32_bf16 a[200:203], v[152:155], v[184:187], a[200:203]
    v_mfma_f32_16x16x32_bf16 a[204:207], v[152:155], v[188:191], a[204:207]
    v_mfma_f32_16x16x32_bf16 a[208:211], v[152:155], v[192:195], a[208:211]
    v_mfma_f32_16x16x32_bf16 a[212:215], v[152:155], v[196:199], a[212:215]
    v_mfma_f32_16x16x32_bf16 a[216:219], v[152:155], v[200:203], a[216:219]
    v_mfma_f32_16x16x32_bf16 a[220:223], v[152:155], v[204:207], a[220:223]
    s_waitcnt lgkmcnt(14)
    v_mfma_f32_16x16x32_bf16 a[200:203], v[156:159], v[180:183], a[200:203]
    v_mfma_f32_16x16x32_bf16 a[204:207], v[156:159], v[184:187], a[204:207]
    buffer_load_dwordx4 v20, s[28:31], s73 offen offset:1024 lds
    v_mfma_f32_16x16x32_bf16 a[208:211], v[156:159], v[188:191], a[208:211]
    v_mfma_f32_16x16x32_bf16 a[212:215], v[156:159], v[192:195], a[212:215]
    v_mfma_f32_16x16x32_bf16 a[216:219], v[156:159], v[196:199], a[216:219]
    v_mfma_f32_16x16x32_bf16 a[220:223], v[156:159], v[200:203], a[220:223]
    s_waitcnt lgkmcnt(12)
    v_mfma_f32_16x16x32_bf16 a[204:207], v[160:163], v[180:183], a[204:207]
    v_mfma_f32_16x16x32_bf16 a[208:211], v[160:163], v[184:187], a[208:211]
    v_mfma_f32_16x16x32_bf16 a[212:215], v[160:163], v[188:191], a[212:215]
    v_mfma_f32_16x16x32_bf16 a[216:219], v[160:163], v[192:195], a[216:219]
    v_mfma_f32_16x16x32_bf16 a[220:223], v[160:163], v[196:199], a[220:223]
    s_waitcnt lgkmcnt(10)
    v_mfma_f32_16x16x32_bf16 a[208:211], v[164:167], v[180:183], a[208:211]
    buffer_load_dwordx4 v21, s[28:31], s73 offen offset:2048 lds
    v_mfma_f32_16x16x32_bf16 a[212:215], v[164:167], v[184:187], a[212:215]
    v_mfma_f32_16x16x32_bf16 a[216:219], v[164:167], v[188:191], a[216:219]
    v_mfma_f32_16x16x32_bf16 a[220:223], v[164:167], v[192:195], a[220:223]
    s_waitcnt lgkmcnt(8)
    v_mfma_f32_16x16x32_bf16 a[212:215], v[168:171], v[180:183], a[212:215]
    v_mfma_f32_16x16x32_bf16 a[216:219], v[168:171], v[184:187], a[216:219]
    v_mfma_f32_16x16x32_bf16 a[220:223], v[168:171], v[188:191], a[220:223]
    s_waitcnt lgkmcnt(6)
    v_mfma_f32_16x16x32_bf16 a[216:219], v[172:175], v[180:183], a[216:219]
    v_mfma_f32_16x16x32_bf16 a[220:223], v[172:175], v[184:187], a[220:223]
    s_waitcnt lgkmcnt(4)
    v_mfma_f32_16x16x32_bf16 a[220:223], v[176:179], v[180:183], a[220:223]
    s_waitcnt lgkmcnt(0)
    s_cmp_eq_u32 s62, 0
    s_cbranch_scc0 L_skip_19
    ds_write_b128 v13, a[208:211] offset:28672
    ds_write_b128 v13, a[212:215] offset:29696
    ds_write_b128 v13, a[216:219] offset:30720
    s_nop 1
    ds_write_b128 v13, a[220:223] offset:31744
    v_accvgpr_read_b32 v212, a192
    v_accvgpr_read_b32 v213, a193
    v_accvgpr_read_b32 v214, a194
    v_accvgpr_read_b32 v215, a195
    v_accvgpr_read_b32 v216, a196
    v_accvgpr_read_b32 v217, a197
    v_accvgpr_read_b32 v218, a198
    v_accvgpr_read_b32 v219, a199
    v_accvgpr_read_b32 v220, a200
    v_accvgpr_read_b32 v221, a201
    v_accvgpr_read_b32 v222, a202
    v_accvgpr_read_b32 v223, a203
    v_accvgpr_read_b32 v224, a204
    v_accvgpr_read_b32 v225, a205
    v_accvgpr_read_b32 v226, a206
    v_accvgpr_read_b32 v227, a207
L_skip_19:
    s_cmp_eq_u32 s62, 1
    s_cbranch_scc0 L_skip_20
    ds_write_b128 v13, a[192:195] offset:28672
    ds_write_b128 v13, a[196:199] offset:29696
    ds_write_b128 v13, a[200:203] offset:30720
    ds_write_b128 v13, a[204:207] offset:31744
    v_accvgpr_read_b32 v212, a208
    v_accvgpr_read_b32 v213, a209
    v_accvgpr_read_b32 v214, a210
    v_accvgpr_read_b32 v215, a211
    v_accvgpr_read_b32 v216, a212
    v_accvgpr_read_b32 v217, a213
    v_accvgpr_read_b32 v218, a214
    v_accvgpr_read_b32 v219, a215
    v_accvgpr_read_b32 v220, a216
    v_accvgpr_read_b32 v221, a217
    v_accvgpr_read_b32 v222, a218
    v_accvgpr_read_b32 v223, a219
    v_accvgpr_read_b32 v224, a220
    v_accvgpr_read_b32 v225, a221
    v_accvgpr_read_b32 v226, a222
    v_accvgpr_read_b32 v227, a223
L_skip_20:
    s_add_u32 m0, s80, 57344
    s_lshl1_add_u32 s73, s86, 2
    s_and_b32 s73, s73, 7
    s_mul_i32 s73, s73, 114688
    s_add_u32 s73, s73, s81
    buffer_load_dwordx4 v19, s[28:31], s73 offen offset:0 lds
    v_and_b32 v148, 0xffff0000, v33
    v_lshlrev_b32 v149, 16, v33
    v_and_b32 v150, 0xffff0000, v32
    v_lshlrev_b32 v151, 16, v32
    v_and_b32 v152, 0xffff0000, v35
    v_lshlrev_b32 v153, 16, v35
    v_and_b32 v154, 0xffff0000, v34
    v_lshlrev_b32 v155, 16, v34
    v_and_b32 v156, 0xffff0000, v37
    v_lshlrev_b32 v157, 16, v37
    v_and_b32 v158, 0xffff0000, v36
    v_lshlrev_b32 v159, 16, v36
    v_and_b32 v160, 0xffff0000, v39
    v_lshlrev_b32 v161, 16, v39
    v_and_b32 v162, 0xffff0000, v38
    v_lshlrev_b32 v163, 16, v38
    s_lshl_b32 s60, s71, 16
    s_and_b32 s61, s71, 0xffff0000
    s_cmp_eq_u32 s63, 0
    s_cselect_b32 s48, s60, s61
    buffer_load_dwordx4 v20, s[28:31], s73 offen offset:1024 lds
    v_pk_fma_f32 v[212:213], v[148:149], s[48:49], v[212:213] op_sel:[0,0,0] op_sel_hi:[1,0,1]
    v_pk_fma_f32 v[214:215], v[150:151], s[48:49], v[214:215] op_sel:[0,0,0] op_sel_hi:[1,0,1]
    v_pk_fma_f32 v[216:217], v[152:153], s[48:49], v[216:217] op_sel:[0,0,0] op_sel_hi:[1,0,1]
    v_pk_fma_f32 v[218:219], v[154:155], s[48:49], v[218:219] op_sel:[0,0,0] op_sel_hi:[1,0,1]
    v_pk_fma_f32 v[220:221], v[156:157], s[48:49], v[220:221] op_sel:[0,0,0] op_sel_hi:[1,0,1]
    v_pk_fma_f32 v[222:223], v[158:159], s[48:49], v[222:223] op_sel:[0,0,0] op_sel_hi:[1,0,1]
    v_pk_fma_f32 v[224:225], v[160:161], s[48:49], v[224:225] op_sel:[0,0,0] op_sel_hi:[1,0,1]
    v_pk_fma_f32 v[226:227], v[162:163], s[48:49], v[226:227] op_sel:[0,0,0] op_sel_hi:[1,0,1]
    s_lshl1_add_u32 s60, s2, s63
    s_lshl1_add_u32 s60, s60, s62
    s_lshl_b32 s60, s60, 11
    s_add_u32 s77, s60, 0x600000
    v_cmp_lt_u32 vcc, 7, v4
    s_waitcnt lgkmcnt(0)
    s_waitcnt vmcnt(6)
    s_barrier
    s_cmp_eq_u32 s3, 0
    s_cbranch_scc0 L_skip_21
    v_mov_b32 v1, s69
    v_mov_b32 v2, 0
    s_mov_b64 exec, 1
    buffer_store_dword v1, v2, s[36:39], s83 offen sc1
    s_mov_b64 exec, -1
L_skip_21:
    ds_read_b128 v[164:167], v14 offset:28672
    ds_read_b128 v[168:171], v14 offset:29696
    ds_read_b128 v[172:175], v14 offset:30720
    buffer_load_dwordx4 v21, s[28:31], s73 offen offset:2048 lds
    ds_read_b128 v[176:179], v14 offset:31744
    s_waitcnt lgkmcnt(0)
    v_pk_add_f32 v[164:165], v[164:165], v[212:213] op_sel:[0,0] op_sel_hi:[1,1]
    v_pk_add_f32 v[166:167], v[166:167], v[214:215] op_sel:[0,0] op_sel_hi:[1,1]
    v_pk_add_f32 v[168:169], v[168:169], v[216:217] op_sel:[0,0] op_sel_hi:[1,1]
    v_pk_add_f32 v[170:171], v[170:171], v[218:219] op_sel:[0,0] op_sel_hi:[1,1]
    v_pk_add_f32 v[172:173], v[172:173], v[220:221] op_sel:[0,0] op_sel_hi:[1,1]
    v_pk_add_f32 v[174:175], v[174:175], v[222:223] op_sel:[0,0] op_sel_hi:[1,1]
    v_pk_add_f32 v[176:177], v[176:177], v[224:225] op_sel:[0,0] op_sel_hi:[1,1]
    v_pk_add_f32 v[178:179], v[178:179], v[226:227] op_sel:[0,0] op_sel_hi:[1,1]
    v_cvt_pk_bf16_f32 v180, v164, v165
    v_cvt_pk_bf16_f32 v181, v166, v167
    v_cvt_pk_bf16_f32 v182, v168, v169
    v_cvt_pk_bf16_f32 v183, v170, v171
    buffer_load_dwordx4 v22, s[28:31], s73 offen offset:3072 lds
    v_cvt_pk_bf16_f32 v184, v172, v173
    v_cvt_pk_bf16_f32 v185, v174, v175
    v_cvt_pk_bf16_f32 v186, v176, v177
    v_cvt_pk_bf16_f32 v187, v178, v179
    v_cndmask_b32 v148, v181, v180, vcc
    v_cndmask_b32 v149, v183, v182, vcc
    v_cndmask_b32 v150, v185, v184, vcc
    v_cndmask_b32 v151, v187, v186, vcc
    v_cndmask_b32 v152, v180, v181, vcc
    v_cndmask_b32 v153, v182, v183, vcc
    v_cndmask_b32 v154, v184, v185, vcc
    v_cndmask_b32 v155, v186, v187, vcc
    v_mov_b32_dpp v148, v148 row_ror:8 row_mask:0xf bank_mask:0xf
    v_mov_b32_dpp v149, v149 row_ror:8 row_mask:0xf bank_mask:0xf
    v_mov_b32_dpp v150, v150 row_ror:8 row_mask:0xf bank_mask:0xf
    s_add_u32 m0, s80, 61440
    s_add_u32 s73, s73, 32768
    buffer_load_dwordx4 v19, s[28:31], s73 offen offset:0 lds
    v_mov_b32_dpp v151, v151 row_ror:8 row_mask:0xf bank_mask:0xf
    v_perm_b32 v180, v148, v152, v47
    v_perm_b32 v181, v149, v153, v47
    v_perm_b32 v182, v150, v154, v47
    v_perm_b32 v183, v151, v155, v47
    v_perm_b32 v184, v148, v152, v48
    v_perm_b32 v185, v149, v153, v48
    v_perm_b32 v186, v150, v154, v48
    v_perm_b32 v187, v151, v155, v48
    ds_write_b128 v45, v[180:183] offset:0
    ds_write_b128 v45, v[184:187] offset:32
    s_waitcnt lgkmcnt(0)
    s_barrier
    buffer_load_dwordx4 v20, s[28:31], s73 offen offset:1024 lds
    ds_read_b128 v[180:183], v46 offset:0
    ds_read_b128 v[184:187], v46 offset:1152
    s_waitcnt lgkmcnt(0)
    s_lshr_b32 s59, s64, 1
    s_lshl_b32 s59, s59, 10
    s_add_u32 s87, s59, 0xf4c000
    s_lshr_b32 s60, s2, 2
    s_lshl_b32 s60, s60, 8
    s_and_b32 s83, s2, 3
    s_lshl2_add_u32 s83, s83, s60
    s_add_u32 s83, s83, 0xf54000
    s_lshl1_add_u32 s58, s64, s63
    s_lshl1_add_u32 s58, s58, s62
    s_mul_i32 s74, s58, 57344
    s_add_u32 s74, s74, 0x800000
    buffer_load_dwordx4 v21, s[28:31], s73 offen offset:2048 lds
    s_add_u32 m0, s80, 86016
    s_lshl1_add_u32 s73, s86, 3
    s_and_b32 s73, s73, 7
    s_mul_i32 s73, s73, 114688
    s_add_u32 s73, s73, s81
    buffer_load_dwordx4 v19, s[28:31], s73 offen offset:0 lds
    buffer_load_dwordx4 v20, s[28:31], s73 offen offset:1024 lds
    buffer_load_dwordx4 v21, s[28:31], s73 offen offset:2048 lds
    buffer_load_dwordx4 v22, s[28:31], s73 offen offset:3072 lds
    s_add_u32 m0, s80, 90112
    s_add_u32 s73, s73, 32768
    buffer_load_dwordx4 v19, s[28:31], s73 offen offset:0 lds
    buffer_load_dwordx4 v20, s[28:31], s73 offen offset:1024 lds
    buffer_load_dwordx4 v21, s[28:31], s73 offen offset:2048 lds
    s_waitcnt vmcnt(0)
    s_cmp_eq_u32 s3, 0
    s_cbranch_scc0 L_skip_22
    v_and_b32 v1, 12, v0
    v_and_b32 v2, 3, v0
    v_lshlrev_b32 v1, 6, v1
    v_lshl_add_u32 v1, v2, 2, v1
    v_add_u32 v15, s87, v1
    s_mov_b32 s72, 32768
L_poll_23:
    buffer_load_dword v1, v15, s[36:39], 0 offen sc1
    s_sub_u32 s72, s72, 1
    s_cbranch_scc1 L_polled_24
    s_waitcnt vmcnt(0)
    v_cmp_ne_u32 vcc, s69, v1
    s_cbranch_vccnz L_poll_23
L_polled_24:
    s_waitcnt vmcnt(0)
L_skip_22:
    s_barrier
    s_add_u32 s75, s86, 0
    s_and_b32 s75, s75, 3
    s_mul_i32 s75, s75, 14336
    s_add_u32 s75, s75, s74
    buffer_load_dwordx4 a[0:3], v11, s[36:39], s75 offen offset:0 sc1
    buffer_load_dwordx4 a[4:7], v11, s[36:39], s75 offen offset:1024 sc1
    buffer_load_dwordx4 a[8:11], v11, s[36:39], s75 offen offset:2048 sc1
    buffer_load_dwordx4 a[12:15], v11, s[36:39], s75 offen offset:3072 sc1
    s_cmp_eq_u32 s2, 0
    s_cbranch_scc0 L_skip_25
    s_mov_b32 s60, 0xf58000
    s_cmp_eq_u32 s3, 0
    s_cbranch_scc0 L_skip_26
    v_mov_b32 v1, s69
    v_mov_b32 v2, 0
    s_mov_b64 exec, 1
    buffer_store_dword v1, v2, s[36:39], s60 offen sc1
    s_mov_b64 exec, -1
L_skip_26:
L_skip_25:
    s_mul_i32 s78, s62, 14336
    s_add_u32 s60, s78, 0
    v_add_u32 v45, s60, v23
    v_add_u32 v46, s60, v24
    v_add_u32 v47, s60, v25
    v_add_u32 v236, s60, v26
    s_add_u32 s60, s78, 28672
    v_add_u32 v237, s60, v23
    v_add_u32 v238, s60, v24
    v_add_u32 v239, s60, v25
    v_add_u32 v240, s60, v26
    ds_read_b64_tr_b16 v[172:173], v45 offset:0
    ds_read_b64_tr_b16 v[174:175], v45 offset:2048
    ds_read_b64_tr_b16 v[176:177], v46 offset:0
    ds_read_b64_tr_b16 v[178:179], v46 offset:2048
    ds_read_b64_tr_b16 v[188:189], v47 offset:0
    ds_read_b64_tr_b16 v[190:191], v47 offset:2048
    ds_read_b64_tr_b16 v[192:193], v236 offset:0
    ds_read_b64_tr_b16 v[194:195], v236 offset:2048
    v_lshlrev_b32 v28, 16, v60
    v_and_b32 v29, 0xffff0000, v60
    v_lshlrev_b32 v116, 16, v76
    v_and_b32 v117, 0xffff0000, v76
    v_lshlrev_b32 v132, 16, v68
    v_and_b32 v133, 0xffff0000, v68
    v_lshlrev_b32 v30, 16, v61
    v_and_b32 v31, 0xffff0000, v61
    v_lshlrev_b32 v118, 16, v77
    v_and_b32 v119, 0xffff0000, v77
    v_lshlrev_b32 v134, 16, v69
    v_and_b32 v135, 0xffff0000, v69
    v_lshlrev_b32 v32, 16, v62
    v_and_b32 v33, 0xffff0000, v62
    v_lshlrev_b32 v120, 16, v78
    v_and_b32 v121, 0xffff0000, v78
    v_lshlrev_b32 v136, 16, v70
    v_and_b32 v137, 0xffff0000, v70
    v_lshlrev_b32 v34, 16, v63
    v_and_b32 v35, 0xffff0000, v63
    v_lshlrev_b32 v122, 16, v79
    v_and_b32 v123, 0xffff0000, v79
    v_lshlrev_b32 v138, 16, v71
    v_and_b32 v139, 0xffff0000, v71
    v_lshlrev_b32 v36, 16, v64
    v_and_b32 v37, 0xffff0000, v64
    v_lshlrev_b32 v124, 16, v80
    v_and_b32 v125, 0xffff0000, v80
    v_lshlrev_b32 v140, 16, v72
    v_and_b32 v141, 0xffff0000, v72
    v_lshlrev_b32 v38, 16, v65
    v_and_b32 v39, 0xffff0000, v65
    v_lshlrev_b32 v126, 16, v81
    v_and_b32 v127, 0xffff0000, v81
    v_lshlrev_b32 v142, 16, v73
    v_and_b32 v143, 0xffff0000, v73
    v_lshlrev_b32 v40, 16, v66
    v_and_b32 v41, 0xffff0000, v66
    v_lshlrev_b32 v128, 16, v82
    v_and_b32 v129, 0xffff0000, v82
    v_lshlrev_b32 v144, 16, v74
    v_and_b32 v145, 0xffff0000, v74
    v_lshlrev_b32 v42, 16, v67
    v_and_b32 v43, 0xffff0000, v67
    v_lshlrev_b32 v130, 16, v83
    v_and_b32 v131, 0xffff0000, v83
    v_lshlrev_b32 v146, 16, v75
    v_and_b32 v147, 0xffff0000, v75
    v_lshrrev_b32 v1, 1, v9
    v_lshl_add_u32 v1, v5, 8, v1
    s_lshl_b32 s58, s3, 11
    s_add_u32 s58, s58, 143360
    v_add3_u32 v12, v1, v10, s58
    v_lshrrev_b32 v1, 2, v3
    v_and_b32 v2, 3, v3
    v_lshlrev_b32 v2, 4, v2
    v_lshl_add_u32 v1, v1, 12, v2
    s_lshl1_add_u32 s58, s65, s62
    s_lshl_b32 s58, s58, 17
    s_lshl1_add_u32 s59, s64, s63
    s_lshl_b32 s59, s59, 6
    s_add_u32 s58, s58, s59
    s_add_u32 s58, s58, 0x600000
    v_add_u32 v16, s58, v1
    s_lshl_b32 s59, s65, 11
    s_add_u32 s59, s59, 0xf54000
    v_and_b32 v1, 28, v0
    v_and_b32 v2, 3, v0
    v_lshlrev_b32 v1, 6, v1
    v_lshl_add_u32 v1, v2, 2, v1
    v_add_u32 v27, s59, v1
    v_and_b32 v1, 1, v5
    v_lshlrev_b32 v1, 5, v1
    v_lshrrev_b32 v2, 1, v5
    v_lshl_add_u32 v1, v2, 4, v1
    v_lshl_add_u32 v1, v4, 17, v1
    s_lshl1_add_u32 s58, s64, s63
    s_lshl_b32 s58, s58, 11
    s_lshl1_add_u32 s59, s65, s62
    s_lshl_b32 s59, s59, 6
    s_add_u32 s58, s58, s59
    v_add_u32 v44, s58, v1
    s_add_u32 s75, s75, 4096
    buffer_load_dwordx4 a[16:19], v11, s[36:39], s75 offen offset:0 sc1
    buffer_load_dwordx4 a[20:23], v11, s[36:39], s75 offen offset:1024 sc1
    buffer_load_dwordx4 v[84:87], v11, s[36:39], s75 offen offset:2048 sc1
    buffer_load_dwordx4 a[24:27], v11, s[36:39], s75 offen offset:3072 sc1
    s_add_u32 s75, s75, 4096
    buffer_load_dwordx4 a[28:31], v11, s[36:39], s75 offen offset:0 sc1
    buffer_load_dwordx4 a[32:35], v11, s[36:39], s75 offen offset:1024 sc1
    s_waitcnt vmcnt(8)
    s_waitcnt lgkmcnt(6)
    v_mfma_f32_16x16x32_bf16 v[48:51], v[172:175], a[0:3], 0
    ds_read_b64_tr_b16 v[196:197], v45 offset:4096
    buffer_store_dwordx4 v[180:183], v11, s[36:39], s77 offen offset:0 sc1
    v_mfma_f32_16x16x32_bf16 v[156:159], v[172:175], a[4:7], 0
    ds_read_b64_tr_b16 v[198:199], v45 offset:6144
    s_waitcnt lgkmcnt(6)
    v_mfma_f32_16x16x32_bf16 v[56:59], v[176:179], a[0:3], 0
    ds_read_b64_tr_b16 v[200:201], v46 offset:4096
    buffer_store_dwordx4 v[184:187], v11, s[36:39], s77 offen offset:1024 sc1
    v_mfma_f32_16x16x32_bf16 v[160:163], v[176:179], a[4:7], 0
    ds_read_b64_tr_b16 v[202:203], v46 offset:6144
    s_waitcnt lgkmcnt(6)
    v_mfma_f32_16x16x32_bf16 v[148:151], v[188:191], a[0:3], 0
    ds_read_b64_tr_b16 v[204:205], v47 offset:4096
    buffer_load_dwordx4 a[36:39], v11, s[36:39], s75 offen offset:2048 sc1
    v_mfma_f32_16x16x32_bf16 v[164:167], v[188:191], a[4:7], 0
    ds_read_b64_tr_b16 v[206:207], v47 offset:6144
    s_waitcnt lgkmcnt(6)
    v_mfma_f32_16x16x32_bf16 v[152:155], v[192:195], a[0:3], 0
    ds_read_b64_tr_b16 v[208:209], v236 offset:4096
    buffer_load_dwordx4 a[40:43], v11, s[36:39], s75 offen offset:3072 sc1
    v_mfma_f32_16x16x32_bf16 v[168:171], v[192:195], a[4:7], 0
    ds_read_b64_tr_b16 v[210:211], v236 offset:6144
    s_waitcnt vmcnt(10)
    s_waitcnt lgkmcnt(6)
    v_mfma_f32_16x16x32_bf16 v[48:51], v[196:199], a[8:11], v[48:51]
    ds_read_b64_tr_b16 v[172:173], v45 offset:8192
    s_add_u32 s75, s75, 4096
    buffer_load_dwordx4 a[44:47], v11, s[36:39], s75 offen offset:0 sc1
    v_mfma_f32_16x16x32_bf16 v[156:159], v[196:199], a[12:15], v[156:159]
    ds_read_b64_tr_b16 v[174:175], v45 offset:10240
    s_waitcnt lgkmcnt(6)
    v_mfma_f32_16x16x32_bf16 v[56:59], v[200:203], a[8:11], v[56:59]
    ds_read_b64_tr_b16 v[176:177], v46 offset:8192
    buffer_load_dwordx4 v[88:91], v11, s[36:39], s75 offen offset:1024 sc1
    v_mfma_f32_16x16x32_bf16 v[160:163], v[200:203], a[12:15], v[160:163]
    ds_read_b64_tr_b16 v[178:179], v46 offset:10240
    s_waitcnt lgkmcnt(6)
    v_mfma_f32_16x16x32_bf16 v[148:151], v[204:207], a[8:11], v[148:151]
    ds_read_b64_tr_b16 v[188:189], v47 offset:8192
    s_add_u32 s75, s86, 1
    s_and_b32 s75, s75, 3
    s_mul_i32 s75, s75, 14336
    s_add_u32 s75, s75, s74
    buffer_load_dwordx4 a[48:51], v11, s[36:39], s75 offen offset:0 sc1
    v_mfma_f32_16x16x32_bf16 v[164:167], v[204:207], a[12:15], v[164:167]
    ds_read_b64_tr_b16 v[190:191], v47 offset:10240
    s_waitcnt lgkmcnt(6)
    v_mfma_f32_16x16x32_bf16 v[152:155], v[208:211], a[8:11], v[152:155]
    ds_read_b64_tr_b16 v[192:193], v236 offset:8192
    buffer_load_dwordx4 a[52:55], v11, s[36:39], s75 offen offset:1024 sc1
    v_mfma_f32_16x16x32_bf16 v[168:171], v[208:211], a[12:15], v[168:171]
    ds_read_b64_tr_b16 v[194:195], v236 offset:10240
    s_waitcnt vmcnt(12)
    s_waitcnt lgkmcnt(6)
    v_mfma_f32_16x16x32_bf16 v[48:51], v[172:175], a[16:19], v[48:51]
    ds_read_b64_tr_b16 v[196:197], v237 offset:0
    buffer_load_dwordx4 a[56:59], v11, s[36:39], s75 offen offset:2048 sc1
    v_mfma_f32_16x16x32_bf16 v[156:159], v[172:175], a[20:23], v[156:159]
    ds_read_b64_tr_b16 v[198:199], v237 offset:2048
    s_waitcnt lgkmcnt(6)
    v_mfma_f32_16x16x32_bf16 v[56:59], v[176:179], a[16:19], v[56:59]
    ds_read_b64_tr_b16 v[200:201], v238 offset:0
    buffer_load_dwordx4 a[60:63], v11, s[36:39], s75 offen offset:3072 sc1
    v_mfma_f32_16x16x32_bf16 v[160:163], v[176:179], a[20:23], v[160:163]
    ds_read_b64_tr_b16 v[202:203], v238 offset:2048
    s_waitcnt lgkmcnt(6)
    v_mfma_f32_16x16x32_bf16 v[148:151], v[188:191], a[16:19], v[148:151]
    ds_read_b64_tr_b16 v[204:205], v239 offset:0
    s_add_u32 s75, s75, 4096
    buffer_load_dwordx4 a[64:67], v11, s[36:39], s75 offen offset:0 sc1
    v_mfma_f32_16x16x32_bf16 v[164:167], v[188:191], a[20:23], v[164:167]
    ds_read_b64_tr_b16 v[206:207], v239 offset:2048
    s_waitcnt lgkmcnt(6)
    v_mfma_f32_16x16x32_bf16 v[152:155], v[192:195], a[16:19], v[152:155]
    ds_read_b64_tr_b16 v[208:209], v240 offset:0
    buffer_load_dwordx4 a[68:71], v11, s[36:39], s75 offen offset:1024 sc1
    v_mfma_f32_16x16x32_bf16 v[168:171], v[192:195], a[20:23], v[168:171]
    ds_read_b64_tr_b16 v[210:211], v240 offset:2048
    s_waitcnt vmcnt(13)
    s_waitcnt lgkmcnt(6)
    v_mfma_f32_16x16x32_bf16 v[48:51], v[196:199], a[24:27], v[48:51]
    ds_read_b64_tr_b16 v[172:173], v237 offset:4096
    buffer_load_dwordx4 v[92:95], v11, s[36:39], s75 offen offset:2048 sc1
    v_mfma_f32_16x16x32_bf16 v[156:159], v[196:199], a[28:31], v[156:159]
    ds_read_b64_tr_b16 v[174:175], v237 offset:6144
    s_waitcnt lgkmcnt(6)
    v_mfma_f32_16x16x32_bf16 v[56:59], v[200:203], a[24:27], v[56:59]
    ds_read_b64_tr_b16 v[176:177], v238 offset:4096
    buffer_load_dwordx4 a[72:75], v11, s[36:39], s75 offen offset:3072 sc1
    v_mfma_f32_16x16x32_bf16 v[160:163], v[200:203], a[28:31], v[160:163]
    ds_read_b64_tr_b16 v[178:179], v238 offset:6144
    s_waitcnt lgkmcnt(6)
    v_mfma_f32_16x16x32_bf16 v[148:151], v[204:207], a[24:27], v[148:151]
    ds_read_b64_tr_b16 v[188:189], v239 offset:4096
    s_add_u32 s75, s75, 4096
    buffer_load_dwordx4 a[76:79], v11, s[36:39], s75 offen offset:0 sc1
    v_mfma_f32_16x16x32_bf16 v[164:167], v[204:207], a[28:31], v[164:167]
    ds_read_b64_tr_b16 v[190:191], v239 offset:6144
    s_waitcnt lgkmcnt(6)
    v_mfma_f32_16x16x32_bf16 v[152:155], v[208:211], a[24:27], v[152:155]
    ds_read_b64_tr_b16 v[192:193], v240 offset:4096
    buffer_load_dwordx4 a[80:83], v11, s[36:39], s75 offen offset:1024 sc1
    v_mfma_f32_16x16x32_bf16 v[168:171], v[208:211], a[28:31], v[168:171]
    ds_read_b64_tr_b16 v[194:195], v240 offset:6144
    s_waitcnt vmcnt(13)
    s_waitcnt lgkmcnt(6)
    v_mfma_f32_16x16x32_bf16 v[48:51], v[172:175], a[32:35], v[48:51]
    ds_read_b64_tr_b16 v[196:197], v237 offset:8192
    buffer_load_dwordx4 a[84:87], v11, s[36:39], s75 offen offset:2048 sc1
    v_mfma_f32_16x16x32_bf16 v[156:159], v[172:175], a[36:39], v[156:159]
    ds_read_b64_tr_b16 v[198:199], v237 offset:10240
    s_waitcnt lgkmcnt(6)
    v_mfma_f32_16x16x32_bf16 v[56:59], v[176:179], a[32:35], v[56:59]
    ds_read_b64_tr_b16 v[200:201], v238 offset:8192
    buffer_load_dwordx4 a[88:91], v11, s[36:39], s75 offen offset:3072 sc1
    v_mfma_f32_16x16x32_bf16 v[160:163], v[176:179], a[36:39], v[160:163]
    ds_read_b64_tr_b16 v[202:203], v238 offset:10240
    s_waitcnt lgkmcnt(6)
    v_mfma_f32_16x16x32_bf16 v[148:151], v[188:191], a[32:35], v[148:151]
    ds_read_b64_tr_b16 v[204:205], v239 offset:8192
    s_add_u32 s75, s75, 4096
    buffer_load_dwordx4 a[92:95], v11, s[36:39], s75 offen offset:0 sc1
    v_mfma_f32_16x16x32_bf16 v[164:167], v[188:191], a[36:39], v[164:167]
    ds_read_b64_tr_b16 v[206:207], v239 offset:10240
    s_waitcnt lgkmcnt(6)
    v_mfma_f32_16x16x32_bf16 v[152:155], v[192:195], a[32:35], v[152:155]
    ds_read_b64_tr_b16 v[208:209], v240 offset:8192
    buffer_load_dwordx4 v[96:99], v11, s[36:39], s75 offen offset:1024 sc1
    v_mfma_f32_16x16x32_bf16 v[168:171], v[192:195], a[36:39], v[168:171]
    ds_read_b64_tr_b16 v[210:211], v240 offset:10240
    s_waitcnt vmcnt(15)
    s_waitcnt lgkmcnt(6)
    v_mfma_f32_16x16x32_bf16 v[48:51], v[196:199], a[40:43], v[48:51]
    ds_read_b64_tr_b16 v[172:173], v45 offset:12288
    s_add_u32 m0, s80, 114688
    s_lshl1_add_u32 s73, s86, 4
    s_and_b32 s73, s73, 7
    s_mul_i32 s73, s73, 114688
    s_add_u32 s73, s73, s81
    buffer_load_dwordx4 v19, s[28:31], s73 offen offset:0 lds
    v_mfma_f32_16x16x32_bf16 v[156:159], v[196:199], a[44:47], v[156:159]
    ds_read_b64_tr_b16 v[174:175], v237 offset:12288
    s_waitcnt lgkmcnt(6)
    v_mfma_f32_16x16x32_bf16 v[56:59], v[200:203], a[40:43], v[56:59]
    ds_read_b64_tr_b16 v[176:177], v46 offset:12288
    buffer_load_dwordx4 v20, s[28:31], s73 offen offset:1024 lds
    v_mfma_f32_16x16x32_bf16 v[160:163], v[200:203], a[44:47], v[160:163]
    ds_read_b64_tr_b16 v[178:179], v238 offset:12288
    s_waitcnt lgkmcnt(6)
    v_mfma_f32_16x16x32_bf16 v[148:151], v[204:207], a[40:43], v[148:151]
    ds_read_b64_tr_b16 v[188:189], v47 offset:12288
    buffer_load_dwordx4 v21, s[28:31], s73 offen offset:2048 lds
    v_mfma_f32_16x16x32_bf16 v[164:167], v[204:207], a[44:47], v[164:167]
    ds_read_b64_tr_b16 v[190:191], v239 offset:12288
    s_waitcnt lgkmcnt(6)
    v_mfma_f32_16x16x32_bf16 v[152:155], v[208:211], a[40:43], v[152:155]
    ds_read_b64_tr_b16 v[192:193], v236 offset:12288
    buffer_load_dwordx4 v22, s[28:31], s73 offen offset:3072 lds
    v_mfma_f32_16x16x32_bf16 v[168:171], v[208:211], a[44:47], v[168:171]
    ds_read_b64_tr_b16 v[194:195], v240 offset:12288
    s_waitcnt vmcnt(18)
    v_swap_b32 v86, v88
    v_swap_b32 v87, v89
    s_waitcnt lgkmcnt(6)
    s_nop 0
    v_mfma_f32_16x16x32_bf16 v[48:51], v[172:175], v[84:87], v[48:51]
    s_add_u32 s60, s78, 57344
    v_add_u32 v45, s60, v23
    s_add_u32 m0, s80, 118784
    s_add_u32 s73, s73, 32768
    buffer_load_dwordx4 v19, s[28:31], s73 offen offset:0 lds
    v_mfma_f32_16x16x32_bf16 v[156:159], v[172:175], v[88:91], v[156:159]
    v_add_u32 v46, s60, v24
    s_waitcnt lgkmcnt(4)
    v_mfma_f32_16x16x32_bf16 v[56:59], v[176:179], v[84:87], v[56:59]
    v_add_u32 v47, s60, v25
    buffer_load_dwordx4 v20, s[28:31], s73 offen offset:1024 lds
    v_mfma_f32_16x16x32_bf16 v[160:163], v[176:179], v[88:91], v[160:163]
    v_add_u32 v236, s60, v26
    s_waitcnt lgkmcnt(2)
    v_mfma_f32_16x16x32_bf16 v[148:151], v[188:191], v[84:87], v[148:151]
    s_add_u32 s60, s78, 86016
    v_add_u32 v237, s60, v23
    v_mfma_f32_16x16x32_bf16 v[164:167], v[188:191], v[88:91], v[164:167]
    v_add_u32 v238, s60, v24
    buffer_load_dwordx4 v21, s[28:31], s73 offen offset:2048 lds
    s_waitcnt lgkmcnt(0)
    v_mfma_f32_16x16x32_bf16 v[152:155], v[192:195], v[84:87], v[152:155]
    v_add_u32 v239, s60, v25
    v_mfma_f32_16x16x32_bf16 v[168:171], v[192:195], v[88:91], v[168:171]
    v_add_u32 v240, s60, v26
    s_barrier
    s_cmp_eq_u32 s3, 0
    s_cbranch_scc0 L_skip_27
    v_mov_b32 v1, s69
    v_mov_b32 v2, 0
    s_mov_b64 exec, 1
    buffer_store_dword v1, v2, s[36:39], s83 offen sc1
    s_mov_b64 exec, -1
L_skip_27:
    ds_read_b64_tr_b16 v[196:197], v45 offset:0
    ds_read_b64_tr_b16 v[198:199], v45 offset:2048
    ds_read_b64_tr_b16 v[200:201], v46 offset:0
    ds_read_b64_tr_b16 v[202:203], v46 offset:2048
    ds_read_b64_tr_b16 v[204:205], v47 offset:0
    ds_read_b64_tr_b16 v[206:207], v47 offset:2048
    ds_read_b64_tr_b16 v[208:209], v236 offset:0
    ds_read_b64_tr_b16 v[210:211], v236 offset:2048
    s_waitcnt vmcnt(19)
    s_waitcnt lgkmcnt(6)
    v_mfma_f32_16x16x32_bf16 v[48:51], v[196:199], a[48:51], v[48:51]
    ds_read_b64_tr_b16 v[172:173], v45 offset:4096
    s_add_u32 m0, s80, 0
    s_lshl1_add_u32 s73, s86, 5
    s_and_b32 s73, s73, 7
    s_mul_i32 s73, s73, 114688
    s_add_u32 s73, s73, s81
    buffer_load_dwordx4 v19, s[28:31], s73 offen offset:0 lds
    v_mfma_f32_16x16x32_bf16 v[156:159], v[196:199], a[52:55], v[156:159]
    ds_read_b64_tr_b16 v[174:175], v45 offset:6144
    s_waitcnt lgkmcnt(6)
    v_mfma_f32_16x16x32_bf16 v[56:59], v[200:203], a[48:51], v[56:59]
    ds_read_b64_tr_b16 v[176:177], v46 offset:4096
    buffer_load_dwordx4 v20, s[28:31], s73 offen offset:1024 lds
    v_mfma_f32_16x16x32_bf16 v[160:163], v[200:203], a[52:55], v[160:163]
    ds_read_b64_tr_b16 v[178:179], v46 offset:6144
    s_waitcnt lgkmcnt(6)
    v_mfma_f32_16x16x32_bf16 v[148:151], v[204:207], a[48:51], v[148:151]
    ds_read_b64_tr_b16 v[188:189], v47 offset:4096
    buffer_load_dwordx4 v21, s[28:31], s73 offen offset:2048 lds
    v_mfma_f32_16x16x32_bf16 v[164:167], v[204:207], a[52:55], v[164:167]
    ds_read_b64_tr_b16 v[190:191], v47 offset:6144
    s_waitcnt lgkmcnt(6)
    v_mfma_f32_16x16x32_bf16 v[152:155], v[208:211], a[48:51], v[152:155]
    ds_read_b64_tr_b16 v[192:193], v236 offset:4096
    buffer_load_dwordx4 v22, s[28:31], s73 offen offset:3072 lds
    v_mfma_f32_16x16x32_bf16 v[168:171], v[208:211], a[52:55], v[168:171]
    ds_read_b64_tr_b16 v[194:195], v236 offset:6144
    s_waitcnt vmcnt(21)
    s_waitcnt lgkmcnt(6)
    v_mfma_f32_16x16x32_bf16 v[48:51], v[172:175], a[56:59], v[48:51]
    ds_read_b64_tr_b16 v[196:197], v45 offset:8192
    s_add_u32 m0, s80, 4096
    s_add_u32 s73, s73, 32768
    buffer_load_dwordx4 v19, s[28:31], s73 offen offset:0 lds
    v_mfma_f32_16x16x32_bf16 v[156:159], v[172:175], a[60:63], v[156:159]
    ds_read_b64_tr_b16 v[198:199], v45 offset:10240
    s_waitcnt lgkmcnt(6)
    v_mfma_f32_16x16x32_bf16 v[56:59], v[176:179], a[56:59], v[56:59]
    ds_read_b64_tr_b16 v[200:201], v46 offset:8192
    buffer_load_dwordx4 v20, s[28:31], s73 offen offset:1024 lds
    v_mfma_f32_16x16x32_bf16 v[160:163], v[176:179], a[60:63], v[160:163]
    ds_read_b64_tr_b16 v[202:203], v46 offset:10240
    s_waitcnt lgkmcnt(6)
    v_mfma_f32_16x16x32_bf16 v[148:151], v[188:191], a[56:59], v[148:151]
    ds_read_b64_tr_b16 v[204:205], v47 offset:8192
    buffer_load_dwordx4 v21, s[28:31], s73 offen offset:2048 lds
    v_mfma_f32_16x16x32_bf16 v[164:167], v[188:191], a[60:63], v[164:167]
    ds_read_b64_tr_b16 v[206:207], v47 offset:10240
    s_waitcnt lgkmcnt(6)
    v_mfma_f32_16x16x32_bf16 v[152:155], v[192:195], a[56:59], v[152:155]
    ds_read_b64_tr_b16 v[208:209], v236 offset:8192
    s_add_u32 s75, s86, 2
    s_and_b32 s75, s75, 3
    s_mul_i32 s75, s75, 14336
    s_add_u32 s75, s75, s74
    buffer_load_dwordx4 a[96:99], v11, s[36:39], s75 offen offset:0 sc1
    v_mfma_f32_16x16x32_bf16 v[168:171], v[192:195], a[60:63], v[168:171]
    ds_read_b64_tr_b16 v[210:211], v236 offset:10240
    s_waitcnt vmcnt(23)
    s_waitcnt lgkmcnt(6)
    v_mfma_f32_16x16x32_bf16 v[48:51], v[196:199], a[64:67], v[48:51]
    ds_read_b64_tr_b16 v[172:173], v237 offset:0
    buffer_load_dwordx4 a[100:103], v11, s[36:39], s75 offen offset:1024 sc1
    v_mfma_f32_16x16x32_bf16 v[156:159], v[196:199], a[68:71], v[156:159]
    ds_read_b64_tr_b16 v[174:175], v237 offset:2048
    s_waitcnt lgkmcnt(6)
    v_mfma_f32_16x16x32_bf16 v[56:59], v[200:203], a[64:67], v[56:59]
    ds_read_b64_tr_b16 v[176:177], v238 offset:0
    buffer_load_dwordx4 a[104:107], v11, s[36:39], s75 offen offset:2048 sc1
    v_mfma_f32_16x16x32_bf16 v[160:163], v[200:203], a[68:71], v[160:163]
    ds_read_b64_tr_b16 v[178:179], v238 offset:2048
    s_waitcnt lgkmcnt(6)
    v_mfma_f32_16x16x32_bf16 v[148:151], v[204:207], a[64:67], v[148:151]
    ds_read_b64_tr_b16 v[188:189], v239 offset:0
    buffer_load_dwordx4 a[108:111], v11, s[36:39], s75 offen offset:3072 sc1
    v_mfma_f32_16x16x32_bf16 v[164:167], v[204:207], a[68:71], v[164:167]
    ds_read_b64_tr_b16 v[190:191], v239 offset:2048
    s_waitcnt lgkmcnt(6)
    v_mfma_f32_16x16x32_bf16 v[152:155], v[208:211], a[64:67], v[152:155]
    ds_read_b64_tr_b16 v[192:193], v240 offset:0
    s_add_u32 s75, s75, 4096
    buffer_load_dwordx4 a[112:115], v11, s[36:39], s75 offen offset:0 sc1
    v_mfma_f32_16x16x32_bf16 v[168:171], v[208:211], a[68:71], v[168:171]
    ds_read_b64_tr_b16 v[194:195], v240 offset:2048
    s_waitcnt vmcnt(24)
    s_waitcnt lgkmcnt(6)
    v_mfma_f32_16x16x32_bf16 v[48:51], v[172:175], a[72:75], v[48:51]
    ds_read_b64_tr_b16 v[196:197], v237 offset:4096
    buffer_load_dwordx4 a[116:119], v11, s[36:39], s75 offen offset:1024 sc1
    v_mfma_f32_16x16x32_bf16 v[156:159], v[172:175], a[76:79], v[156:159]
    ds_read_b64_tr_b16 v[198:199], v237 offset:6144
    s_waitcnt lgkmcnt(6)
    v_mfma_f32_16x16x32_bf16 v[56:59], v[176:179], a[72:75], v[56:59]
    ds_read_b64_tr_b16 v[200:201], v238 offset:4096
    buffer_load_dwordx4 v[100:103], v11, s[36:39], s75 offen offset:2048 sc1
    v_mfma_f32_16x16x32_bf16 v[160:163], v[176:179], a[76:79], v[160:163]
    ds_read_b64_tr_b16 v[202:203], v238 offset:6144
    s_waitcnt lgkmcnt(6)
    v_mfma_f32_16x16x32_bf16 v[148:151], v[188:191], a[72:75], v[148:151]
    ds_read_b64_tr_b16 v[204:205], v239 offset:4096
    buffer_load_dwordx4 a[120:123], v11, s[36:39], s75 offen offset:3072 sc1
    v_mfma_f32_16x16x32_bf16 v[164:167], v[188:191], a[76:79], v[164:167]
    ds_read_b64_tr_b16 v[206:207], v239 offset:6144
    s_waitcnt lgkmcnt(6)
    v_mfma_f32_16x16x32_bf16 v[152:155], v[192:195], a[72:75], v[152:155]
    ds_read_b64_tr_b16 v[208:209], v240 offset:4096
    s_add_u32 s75, s75, 4096
    buffer_load_dwordx4 a[124:127], v11, s[36:39], s75 offen offset:0 sc1
    v_mfma_f32_16x16x32_bf16 v[168:171], v[192:195], a[76:79], v[168:171]
    ds_read_b64_tr_b16 v[210:211], v240 offset:6144
    s_waitcnt vmcnt(26)
    s_waitcnt lgkmcnt(6)
    v_mfma_f32_16x16x32_bf16 v[48:51], v[196:199], a[80:83], v[48:51]
    ds_read_b64_tr_b16 v[172:173], v237 offset:8192
    buffer_load_dwordx4 a[128:131], v11, s[36:39], s75 offen offset:1024 sc1
    v_mfma_f32_16x16x32_bf16 v[156:159], v[196:199], a[84:87], v[156:159]
    ds_read_b64_tr_b16 v[174:175], v237 offset:10240
    s_waitcnt lgkmcnt(6)
    v_mfma_f32_16x16x32_bf16 v[56:59], v[200:203], a[80:83], v[56:59]
    ds_read_b64_tr_b16 v[176:177], v238 offset:8192
    buffer_load_dwordx4 a[132:135], v11, s[36:39], s75 offen offset:2048 sc1
    v_mfma_f32_16x16x32_bf16 v[160:163], v[200:203], a[84:87], v[160:163]
    ds_read_b64_tr_b16 v[178:179], v238 offset:10240
    s_waitcnt lgkmcnt(6)
    v_mfma_f32_16x16x32_bf16 v[148:151], v[204:207], a[80:83], v[148:151]
    ds_read_b64_tr_b16 v[188:189], v239 offset:8192
    buffer_load_dwordx4 a[136:139], v11, s[36:39], s75 offen offset:3072 sc1
    v_mfma_f32_16x16x32_bf16 v[164:167], v[204:207], a[84:87], v[164:167]
    ds_read_b64_tr_b16 v[190:191], v239 offset:10240
    s_waitcnt lgkmcnt(6)
    v_mfma_f32_16x16x32_bf16 v[152:155], v[208:211], a[80:83], v[152:155]
    ds_read_b64_tr_b16 v[192:193], v240 offset:8192
    s_add_u32 s75, s75, 4096
    buffer_load_dwordx4 a[140:143], v11, s[36:39], s75 offen offset:0 sc1
    v_mfma_f32_16x16x32_bf16 v[168:171], v[208:211], a[84:87], v[168:171]
    ds_read_b64_tr_b16 v[194:195], v240 offset:10240
    s_waitcnt vmcnt(28)
    s_waitcnt lgkmcnt(6)
    v_mfma_f32_16x16x32_bf16 v[48:51], v[172:175], a[88:91], v[48:51]
    ds_read_b64_tr_b16 v[196:197], v45 offset:12288
    buffer_load_dwordx4 v[104:107], v11, s[36:39], s75 offen offset:1024 sc1
    v_mfma_f32_16x16x32_bf16 v[156:159], v[172:175], a[92:95], v[156:159]
    ds_read_b64_tr_b16 v[198:199], v237 offset:12288
    s_waitcnt lgkmcnt(6)
    v_mfma_f32_16x16x32_bf16 v[56:59], v[176:179], a[88:91], v[56:59]
    ds_read_b64_tr_b16 v[200:201], v46 offset:12288
    s_add_u32 m0, s80, 28672
    s_lshl1_add_u32 s73, s86, 6
    s_and_b32 s73, s73, 7
    s_mul_i32 s73, s73, 114688
    s_add_u32 s73, s73, s81
    buffer_load_dwordx4 v19, s[28:31], s73 offen offset:0 lds
    v_mfma_f32_16x16x32_bf16 v[160:163], v[176:179], a[92:95], v[160:163]
    ds_read_b64_tr_b16 v[202:203], v238 offset:12288
    s_waitcnt lgkmcnt(6)
    v_mfma_f32_16x16x32_bf16 v[148:151], v[188:191], a[88:91], v[148:151]
    ds_read_b64_tr_b16 v[204:205], v47 offset:12288
    buffer_load_dwordx4 v20, s[28:31], s73 offen offset:1024 lds
    v_mfma_f32_16x16x32_bf16 v[164:167], v[188:191], a[92:95], v[164:167]
    ds_read_b64_tr_b16 v[206:207], v239 offset:12288
    s_waitcnt lgkmcnt(6)
    v_mfma_f32_16x16x32_bf16 v[152:155], v[192:195], a[88:91], v[152:155]
    ds_read_b64_tr_b16 v[208:209], v236 offset:12288
    buffer_load_dwordx4 v21, s[28:31], s73 offen offset:2048 lds
    v_mfma_f32_16x16x32_bf16 v[168:171], v[192:195], a[92:95], v[168:171]
    ds_read_b64_tr_b16 v[210:211], v240 offset:12288
    s_waitcnt vmcnt(31)
    v_swap_b32 v94, v96
    v_swap_b32 v95, v97
    s_waitcnt lgkmcnt(6)
    s_nop 0
    v_mfma_f32_16x16x32_bf16 v[48:51], v[196:199], v[92:95], v[48:51]
    s_add_u32 s60, s78, 114688
    v_add_u32 v45, s60, v23
    buffer_load_dwordx4 v22, s[28:31], s73 offen offset:3072 lds
    v_mfma_f32_16x16x32_bf16 v[156:159], v[196:199], v[96:99], v[156:159]
    v_add_u32 v46, s60, v24
    s_waitcnt lgkmcnt(4)
    v_mfma_f32_16x16x32_bf16 v[56:59], v[200:203], v[92:95], v[56:59]
    v_add_u32 v47, s60, v25
    s_add_u32 m0, s80, 32768
    s_add_u32 s73, s73, 32768
    buffer_load_dwordx4 v19, s[28:31], s73 offen offset:0 lds
    v_mfma_f32_16x16x32_bf16 v[160:163], v[200:203], v[96:99], v[160:163]
    v_add_u32 v236, s60, v26
    s_waitcnt lgkmcnt(2)
    v_mfma_f32_16x16x32_bf16 v[148:151], v[204:207], v[92:95], v[148:151]
    s_add_u32 s60, s78, 0
    v_add_u32 v237, s60, v23
    buffer_load_dwordx4 v20, s[28:31], s73 offen offset:1024 lds
    v_mfma_f32_16x16x32_bf16 v[164:167], v[204:207], v[96:99], v[164:167]
    v_add_u32 v238, s60, v24
    s_waitcnt lgkmcnt(0)
    v_mfma_f32_16x16x32_bf16 v[152:155], v[208:211], v[92:95], v[152:155]
    v_add_u32 v239, s60, v25
    buffer_load_dwordx4 v21, s[28:31], s73 offen offset:2048 lds
    v_mfma_f32_16x16x32_bf16 v[168:171], v[208:211], v[96:99], v[168:171]
    v_add_u32 v240, s60, v26
    s_waitcnt vmcnt(21)
    s_barrier
    ds_read_b64_tr_b16 v[172:173], v45 offset:0
    ds_read_b64_tr_b16 v[174:175], v45 offset:2048
    ds_read_b64_tr_b16 v[176:177], v46 offset:0
    ds_read_b64_tr_b16 v[178:179], v46 offset:2048
    ds_read_b64_tr_b16 v[188:189], v47 offset:0
    ds_read_b64_tr_b16 v[190:191], v47 offset:2048
    ds_read_b64_tr_b16 v[192:193], v236 offset:0
    ds_read_b64_tr_b16 v[194:195], v236 offset:2048
    s_waitcnt vmcnt(19)
    s_waitcnt lgkmcnt(6)
    v_mfma_f32_16x16x32_bf16 v[48:51], v[172:175], a[96:99], v[48:51]
    ds_read_b64_tr_b16 v[196:197], v45 offset:4096
    s_add_u32 m0, s80, 57344
    s_lshl1_add_u32 s73, s86, 7
    s_and_b32 s73, s73, 7
    s_mul_i32 s73, s73, 114688
    s_add_u32 s73, s73, s81
    buffer_load_dwordx4 v19, s[28:31], s73 offen offset:0 lds
    v_mfma_f32_16x16x32_bf16 v[156:159], v[172:175], a[100:103], v[156:159]
    ds_read_b64_tr_b16 v[198:199], v45 offset:6144
    s_waitcnt lgkmcnt(6)
    v_mfma_f32_16x16x32_bf16 v[56:59], v[176:179], a[96:99], v[56:59]
    ds_read_b64_tr_b16 v[200:201], v46 offset:4096
    buffer_load_dwordx4 v20, s[28:31], s73 offen offset:1024 lds
    v_mfma_f32_16x16x32_bf16 v[160:163], v[176:179], a[100:103], v[160:163]
    ds_read_b64_tr_b16 v[202:203], v46 offset:6144
    s_waitcnt lgkmcnt(6)
    v_mfma_f32_16x16x32_bf16 v[148:151], v[188:191], a[96:99], v[148:151]
    ds_read_b64_tr_b16 v[204:205], v47 offset:4096
    v_mfma_f32_16x16x32_bf16 v[164:167], v[188:191], a[100:103], v[164:167]
    ds_read_b64_tr_b16 v[206:207], v47 offset:6144
    buffer_load_dwordx4 v21, s[28:31], s73 offen offset:2048 lds
    s_waitcnt lgkmcnt(6)
    v_mfma_f32_16x16x32_bf16 v[152:155], v[192:195], a[96:99], v[152:155]
    ds_read_b64_tr_b16 v[208:209], v236 offset:4096
    v_mfma_f32_16x16x32_bf16 v[168:171], v[192:195], a[100:103], v[168:171]
    ds_read_b64_tr_b16 v[210:211], v236 offset:6144
    s_waitcnt vmcnt(20)
    s_waitcnt lgkmcnt(6)
    v_mfma_f32_16x16x32_bf16 v[48:51], v[196:199], a[104:107], v[48:51]
    ds_read_b64_tr_b16 v[172:173], v45 offset:8192
    buffer_load_dwordx4 v22, s[28:31], s73 offen offset:3072 lds
    v_mfma_f32_16x16x32_bf16 v[156:159], v[196:199], a[108:111], v[156:159]
    ds_read_b64_tr_b16 v[174:175], v45 offset:10240
    s_waitcnt lgkmcnt(6)
    v_mfma_f32_16x16x32_bf16 v[56:59], v[200:203], a[104:107], v[56:59]
    ds_read_b64_tr_b16 v[176:177], v46 offset:8192
    s_add_u32 m0, s80, 61440
    s_add_u32 s73, s73, 32768
    buffer_load_dwordx4 v19, s[28:31], s73 offen offset:0 lds
    v_mfma_f32_16x16x32_bf16 v[160:163], v[200:203], a[108:111], v[160:163]
    ds_read_b64_tr_b16 v[178:179], v46 offset:10240
    s_waitcnt lgkmcnt(6)
    v_mfma_f32_16x16x32_bf16 v[148:151], v[204:207], a[104:107], v[148:151]
    ds_read_b64_tr_b16 v[188:189], v47 offset:8192
    v_mfma_f32_16x16x32_bf16 v[164:167], v[204:207], a[108:111], v[164:167]
    ds_read_b64_tr_b16 v[190:191], v47 offset:10240
    buffer_load_dwordx4 v20, s[28:31], s73 offen offset:1024 lds
    s_waitcnt lgkmcnt(6)
    v_mfma_f32_16x16x32_bf16 v[152:155], v[208:211], a[104:107], v[152:155]
    ds_read_b64_tr_b16 v[192:193], v236 offset:8192
    v_mfma_f32_16x16x32_bf16 v[168:171], v[208:211], a[108:111], v[168:171]
    ds_read_b64_tr_b16 v[194:195], v236 offset:10240
    s_waitcnt vmcnt(21)
    s_waitcnt lgkmcnt(6)
    v_mfma_f32_16x16x32_bf16 v[48:51], v[172:175], a[112:115], v[48:51]
    ds_read_b64_tr_b16 v[196:197], v237 offset:0
    buffer_load_dwordx4 v21, s[28:31], s73 offen offset:2048 lds
    v_mfma_f32_16x16x32_bf16 v[156:159], v[172:175], a[116:119], v[156:159]
    ds_read_b64_tr_b16 v[198:199], v237 offset:2048
    s_waitcnt lgkmcnt(6)
    v_mfma_f32_16x16x32_bf16 v[56:59], v[176:179], a[112:115], v[56:59]
    ds_read_b64_tr_b16 v[200:201], v238 offset:0
    s_add_u32 s75, s86, 3
    s_and_b32 s75, s75, 3
    s_mul_i32 s75, s75, 14336
    s_add_u32 s75, s75, s74
    buffer_load_dwordx4 a[144:147], v11, s[36:39], s75 offen offset:0 sc1
    v_mfma_f32_16x16x32_bf16 v[160:163], v[176:179], a[116:119], v[160:163]
    ds_read_b64_tr_b16 v[202:203], v238 offset:2048
    s_waitcnt lgkmcnt(6)
    v_mfma_f32_16x16x32_bf16 v[148:151], v[188:191], a[112:115], v[148:151]
    ds_read_b64_tr_b16 v[204:205], v239 offset:0
    v_mfma_f32_16x16x32_bf16 v[164:167], v[188:191], a[116:119], v[164:167]
    ds_read_b64_tr_b16 v[206:207], v239 offset:2048
    buffer_load_dwordx4 a[148:151], v11, s[36:39], s75 offen offset:1024 sc1
    s_waitcnt lgkmcnt(6)
    v_mfma_f32_16x16x32_bf16 v[152:155], v[192:195], a[112:115], v[152:155]
    ds_read_b64_tr_b16 v[208:209], v240 offset:0
    v_mfma_f32_16x16x32_bf16 v[168:171], v[192:195], a[116:119], v[168:171]
    ds_read_b64_tr_b16 v[210:211], v240 offset:2048
    s_waitcnt vmcnt(21)
    s_waitcnt lgkmcnt(6)
    v_mfma_f32_16x16x32_bf16 v[48:51], v[196:199], a[120:123], v[48:51]
    ds_read_b64_tr_b16 v[172:173], v237 offset:4096
    buffer_load_dwordx4 a[152:155], v11, s[36:39], s75 offen offset:2048 sc1
    v_mfma_f32_16x16x32_bf16 v[156:159], v[196:199], a[124:127], v[156:159]
    ds_read_b64_tr_b16 v[174:175], v237 offset:6144
    s_waitcnt lgkmcnt(6)
    v_mfma_f32_16x16x32_bf16 v[56:59], v[200:203], a[120:123], v[56:59]
    ds_read_b64_tr_b16 v[176:177], v238 offset:4096
    buffer_load_dwordx4 a[156:159], v11, s[36:39], s75 offen offset:3072 sc1
    v_mfma_f32_16x16x32_bf16 v[160:163], v[200:203], a[124:127], v[160:163]
    ds_read_b64_tr_b16 v[178:179], v238 offset:6144
    s_waitcnt lgkmcnt(6)
    v_mfma_f32_16x16x32_bf16 v[148:151], v[204:207], a[120:123], v[148:151]
    ds_read_b64_tr_b16 v[188:189], v239 offset:4096
    v_mfma_f32_16x16x32_bf16 v[164:167], v[204:207], a[124:127], v[164:167]
    ds_read_b64_tr_b16 v[190:191], v239 offset:6144
    buffer_load_dword v17, v27, s[36:39], 0 offen sc1
    s_waitcnt lgkmcnt(6)
    v_mfma_f32_16x16x32_bf16 v[152:155], v[208:211], a[120:123], v[152:155]
    ds_read_b64_tr_b16 v[192:193], v240 offset:4096
    v_mfma_f32_16x16x32_bf16 v[168:171], v[208:211], a[124:127], v[168:171]
    ds_read_b64_tr_b16 v[194:195], v240 offset:6144
    s_waitcnt vmcnt(22)
    s_waitcnt lgkmcnt(6)
    v_mfma_f32_16x16x32_bf16 v[48:51], v[172:175], a[128:131], v[48:51]
    ds_read_b64_tr_b16 v[196:197], v237 offset:8192
    s_add_u32 s75, s75, 4096
    buffer_load_dwordx4 a[160:163], v11, s[36:39], s75 offen offset:0 sc1
    v_mfma_f32_16x16x32_bf16 v[156:159], v[172:175], a[132:135], v[156:159]
    ds_read_b64_tr_b16 v[198:199], v237 offset:10240
    s_waitcnt lgkmcnt(6)
    v_mfma_f32_16x16x32_bf16 v[56:59], v[176:179], a[128:131], v[56:59]
    ds_read_b64_tr_b16 v[200:201], v238 offset:8192
    v_mfma_f32_16x16x32_bf16 v[160:163], v[176:179], a[132:135], v[160:163]
    ds_read_b64_tr_b16 v[202:203], v238 offset:10240
    s_waitcnt lgkmcnt(6)
    v_mfma_f32_16x16x32_bf16 v[148:151], v[188:191], a[128:131], v[148:151]
    ds_read_b64_tr_b16 v[204:205], v239 offset:8192
    buffer_load_dwordx4 a[164:167], v11, s[36:39], s75 offen offset:1024 sc1
    v_mfma_f32_16x16x32_bf16 v[164:167], v[188:191], a[132:135], v[164:167]
    ds_read_b64_tr_b16 v[206:207], v239 offset:10240
    s_waitcnt lgkmcnt(6)
    v_mfma_f32_16x16x32_bf16 v[152:155], v[192:195], a[128:131], v[152:155]
    ds_read_b64_tr_b16 v[208:209], v240 offset:8192
    v_mfma_f32_16x16x32_bf16 v[168:171], v[192:195], a[132:135], v[168:171]
    ds_read_b64_tr_b16 v[210:211], v240 offset:10240
    s_waitcnt vmcnt(22)
    s_waitcnt lgkmcnt(6)
    v_mfma_f32_16x16x32_bf16 v[48:51], v[196:199], a[136:139], v[48:51]
    ds_read_b64_tr_b16 v[172:173], v45 offset:12288
    buffer_load_dwordx4 v[108:111], v11, s[36:39], s75 offen offset:2048 sc1
    v_mfma_f32_16x16x32_bf16 v[156:159], v[196:199], a[140:143], v[156:159]
    ds_read_b64_tr_b16 v[174:175], v237 offset:12288
    s_waitcnt lgkmcnt(6)
    v_mfma_f32_16x16x32_bf16 v[56:59], v[200:203], a[136:139], v[56:59]
    ds_read_b64_tr_b16 v[176:177], v46 offset:12288
    v_mfma_f32_16x16x32_bf16 v[160:163], v[200:203], a[140:143], v[160:163]
    ds_read_b64_tr_b16 v[178:179], v238 offset:12288
    s_waitcnt lgkmcnt(6)
    v_mfma_f32_16x16x32_bf16 v[148:151], v[204:207], a[136:139], v[148:151]
    ds_read_b64_tr_b16 v[188:189], v47 offset:12288
    buffer_load_dwordx4 a[168:171], v11, s[36:39], s75 offen offset:3072 sc1
    v_mfma_f32_16x16x32_bf16 v[164:167], v[204:207], a[140:143], v[164:167]
    ds_read_b64_tr_b16 v[190:191], v239 offset:12288
    s_waitcnt lgkmcnt(6)
    v_mfma_f32_16x16x32_bf16 v[152:155], v[208:211], a[136:139], v[152:155]
    ds_read_b64_tr_b16 v[192:193], v236 offset:12288
    v_mfma_f32_16x16x32_bf16 v[168:171], v[208:211], a[140:143], v[168:171]
    ds_read_b64_tr_b16 v[194:195], v240 offset:12288
    s_waitcnt vmcnt(23)
    v_swap_b32 v102, v104
    v_swap_b32 v103, v105
    s_waitcnt lgkmcnt(6)
    s_nop 0
    v_mfma_f32_16x16x32_bf16 v[48:51], v[172:175], v[100:103], v[48:51]
    s_add_u32 s60, s78, 28672
    v_add_u32 v45, s60, v23
    s_add_u32 s75, s75, 4096
    buffer_load_dwordx4 a[172:175], v11, s[36:39], s75 offen offset:0 sc1
    v_mfma_f32_16x16x32_bf16 v[156:159], v[172:175], v[104:107], v[156:159]
    v_add_u32 v46, s60, v24
    s_waitcnt lgkmcnt(4)
    v_mfma_f32_16x16x32_bf16 v[56:59], v[176:179], v[100:103], v[56:59]
    v_add_u32 v47, s60, v25
    v_mfma_f32_16x16x32_bf16 v[160:163], v[176:179], v[104:107], v[160:163]
    v_add_u32 v236, s60, v26
    s_waitcnt lgkmcnt(2)
    v_mfma_f32_16x16x32_bf16 v[148:151], v[188:191], v[100:103], v[148:151]
    s_add_u32 s60, s78, 57344
    v_add_u32 v237, s60, v23
    buffer_load_dwordx4 a[176:179], v11, s[36:39], s75 offen offset:1024 sc1
    v_mfma_f32_16x16x32_bf16 v[164:167], v[188:191], v[104:107], v[164:167]
    v_add_u32 v238, s60, v24
    s_waitcnt lgkmcnt(0)
    v_mfma_f32_16x16x32_bf16 v[152:155], v[192:195], v[100:103], v[152:155]
    v_add_u32 v239, s60, v25
    v_mfma_f32_16x16x32_bf16 v[168:171], v[192:195], v[104:107], v[168:171]
    v_add_u32 v240, s60, v26
    s_waitcnt vmcnt(11)
    s_barrier
    s_waitcnt vmcnt(6)
    v_cmp_ne_u32 vcc, s69, v17
    s_cbranch_vccz L_yok_28
    s_mov_b32 s72, 32768
L_poll_29:
    buffer_load_dword v1, v27, s[36:39], 0 offen sc1
    s_sub_u32 s72, s72, 1
    s_cbranch_scc1 L_polled_30
    s_waitcnt vmcnt(0)
    v_cmp_ne_u32 vcc, s69, v1
    s_cbranch_vccnz L_poll_29
L_polled_30:
    s_waitcnt vmcnt(0)
L_yok_28:
    ds_read_b64_tr_b16 v[196:197], v45 offset:0
    ds_read_b64_tr_b16 v[198:199], v45 offset:2048
    ds_read_b64_tr_b16 v[200:201], v46 offset:0
    ds_read_b64_tr_b16 v[202:203], v46 offset:2048
    ds_read_b64_tr_b16 v[204:205], v47 offset:0
    ds_read_b64_tr_b16 v[206:207], v47 offset:2048
    ds_read_b64_tr_b16 v[208:209], v236 offset:0
    ds_read_b64_tr_b16 v[210:211], v236 offset:2048
    s_waitcnt lgkmcnt(6)
    v_mfma_f32_16x16x32_bf16 v[48:51], v[196:199], a[144:147], v[48:51]
    ds_read_b64_tr_b16 v[172:173], v45 offset:4096
    buffer_load_dwordx4 a[180:183], v11, s[36:39], s75 offen offset:2048 sc1
    v_mfma_f32_16x16x32_bf16 v[156:159], v[196:199], a[148:151], v[156:159]
    ds_read_b64_tr_b16 v[174:175], v45 offset:6144
    s_waitcnt lgkmcnt(6)
    v_mfma_f32_16x16x32_bf16 v[56:59], v[200:203], a[144:147], v[56:59]
    ds_read_b64_tr_b16 v[176:177], v46 offset:4096
    buffer_load_dwordx4 a[184:187], v11, s[36:39], s75 offen offset:3072 sc1
    v_mfma_f32_16x16x32_bf16 v[160:163], v[200:203], a[148:151], v[160:163]
    ds_read_b64_tr_b16 v[178:179], v46 offset:6144
    s_waitcnt lgkmcnt(6)
    v_mfma_f32_16x16x32_bf16 v[148:151], v[204:207], a[144:147], v[148:151]
    ds_read_b64_tr_b16 v[188:189], v47 offset:4096
    v_mfma_f32_16x16x32_bf16 v[164:167], v[204:207], a[148:151], v[164:167]
    ds_read_b64_tr_b16 v[190:191], v47 offset:6144
    s_add_u32 s75, s75, 4096
    buffer_load_dwordx4 a[188:191], v11, s[36:39], s75 offen offset:0 sc1
    s_waitcnt lgkmcnt(6)
    v_mfma_f32_16x16x32_bf16 v[152:155], v[208:211], a[144:147], v[152:155]
    ds_read_b64_tr_b16 v[192:193], v236 offset:4096
    v_mfma_f32_16x16x32_bf16 v[168:171], v[208:211], a[148:151], v[168:171]
    ds_read_b64_tr_b16 v[194:195], v236 offset:6144
    s_waitcnt lgkmcnt(6)
    v_mfma_f32_16x16x32_bf16 v[48:51], v[172:175], a[152:155], v[48:51]
    ds_read_b64_tr_b16 v[196:197], v45 offset:8192
    buffer_load_dwordx4 v[112:115], v11, s[36:39], s75 offen offset:1024 sc1
    v_mfma_f32_16x16x32_bf16 v[156:159], v[172:175], a[156:159], v[156:159]
    ds_read_b64_tr_b16 v[198:199], v45 offset:10240
    s_waitcnt lgkmcnt(6)
    v_mfma_f32_16x16x32_bf16 v[56:59], v[176:179], a[152:155], v[56:59]
    ds_read_b64_tr_b16 v[200:201], v46 offset:8192
    s_lshl_b32 s73, s3, 11
    s_add_u32 m0, s73, 143360
    s_mov_b32 s73, 64512
    buffer_load_dwordx4 v16, s[36:39], 0 offen sc1 lds
    v_mfma_f32_16x16x32_bf16 v[160:163], v[176:179], a[156:159], v[160:163]
    ds_read_b64_tr_b16 v[202:203], v46 offset:10240
    s_waitcnt lgkmcnt(6)
    v_mfma_f32_16x16x32_bf16 v[148:151], v[188:191], a[152:155], v[148:151]
    ds_read_b64_tr_b16 v[204:205], v47 offset:8192
    v_mfma_f32_16x16x32_bf16 v[164:167], v[188:191], a[156:159], v[164:167]
    ds_read_b64_tr_b16 v[206:207], v47 offset:10240
    buffer_load_dwordx4 v16, s[36:39], s73 offen offset:1024 sc1 lds
    s_waitcnt lgkmcnt(6)
    v_mfma_f32_16x16x32_bf16 v[152:155], v[192:195], a[152:155], v[152:155]
    ds_read_b64_tr_b16 v[208:209], v236 offset:8192
    v_mfma_f32_16x16x32_bf16 v[168:171], v[192:195], a[156:159], v[168:171]
    ds_read_b64_tr_b16 v[210:211], v236 offset:10240
    s_waitcnt vmcnt(10)
    s_waitcnt lgkmcnt(6)
    v_mfma_f32_16x16x32_bf16 v[48:51], v[196:199], a[160:163], v[48:51]
    ds_read_b64_tr_b16 v[172:173], v237 offset:0
    v_mfma_f32_16x16x32_bf16 v[156:159], v[196:199], a[164:167], v[156:159]
    ds_read_b64_tr_b16 v[174:175], v237 offset:2048
    s_waitcnt lgkmcnt(6)
    v_mfma_f32_16x16x32_bf16 v[56:59], v[200:203], a[160:163], v[56:59]
    ds_read_b64_tr_b16 v[176:177], v238 offset:0
    v_mfma_f32_16x16x32_bf16 v[160:163], v[200:203], a[164:167], v[160:163]
    ds_read_b64_tr_b16 v[178:179], v238 offset:2048
    s_waitcnt lgkmcnt(6)
    v_mfma_f32_16x16x32_bf16 v[148:151], v[204:207], a[160:163], v[148:151]
    ds_read_b64_tr_b16 v[188:189], v239 offset:0
    v_mfma_f32_16x16x32_bf16 v[164:167], v[204:207], a[164:167], v[164:167]
    ds_read_b64_tr_b16 v[190:191], v239 offset:2048
    s_waitcnt lgkmcnt(6)
    v_mfma_f32_16x16x32_bf16 v[152:155], v[208:211], a[160:163], v[152:155]
    ds_read_b64_tr_b16 v[192:193], v240 offset:0
    v_mfma_f32_16x16x32_bf16 v[168:171], v[208:211], a[164:167], v[168:171]
    ds_read_b64_tr_b16 v[194:195], v240 offset:2048
    s_waitcnt vmcnt(7)
    s_waitcnt lgkmcnt(6)
    v_mfma_f32_16x16x32_bf16 v[48:51], v[172:175], a[168:171], v[48:51]
    ds_read_b64_tr_b16 v[196:197], v237 offset:4096
    v_mfma_f32_16x16x32_bf16 v[156:159], v[172:175], a[172:175], v[156:159]
    ds_read_b64_tr_b16 v[198:199], v237 offset:6144
    s_waitcnt lgkmcnt(6)
    v_mfma_f32_16x16x32_bf16 v[56:59], v[176:179], a[168:171], v[56:59]
    ds_read_b64_tr_b16 v[200:201], v238 offset:4096
    v_mfma_f32_16x16x32_bf16 v[160:163], v[176:179], a[172:175], v[160:163]
    ds_read_b64_tr_b16 v[202:203], v238 offset:6144
    s_waitcnt lgkmcnt(6)
    v_mfma_f32_16x16x32_bf16 v[148:151], v[188:191], a[168:171], v[148:151]
    ds_read_b64_tr_b16 v[204:205], v239 offset:4096
    v_mfma_f32_16x16x32_bf16 v[164:167], v[188:191], a[172:175], v[164:167]
    ds_read_b64_tr_b16 v[206:207], v239 offset:6144
    s_waitcnt lgkmcnt(6)
    v_mfma_f32_16x16x32_bf16 v[152:155], v[192:195], a[168:171], v[152:155]
    ds_read_b64_tr_b16 v[208:209], v240 offset:4096
    v_mfma_f32_16x16x32_bf16 v[168:171], v[192:195], a[172:175], v[168:171]
    ds_read_b64_tr_b16 v[210:211], v240 offset:6144
    s_waitcnt vmcnt(5)
    s_waitcnt lgkmcnt(6)
    v_mfma_f32_16x16x32_bf16 v[48:51], v[196:199], a[176:179], v[48:51]
    ds_read_b64_tr_b16 v[172:173], v237 offset:8192
    v_mfma_f32_16x16x32_bf16 v[156:159], v[196:199], a[180:183], v[156:159]
    ds_read_b64_tr_b16 v[174:175], v237 offset:10240
    s_waitcnt lgkmcnt(6)
    v_mfma_f32_16x16x32_bf16 v[56:59], v[200:203], a[176:179], v[56:59]
    ds_read_b64_tr_b16 v[176:177], v238 offset:8192
    v_mfma_f32_16x16x32_bf16 v[160:163], v[200:203], a[180:183], v[160:163]
    ds_read_b64_tr_b16 v[178:179], v238 offset:10240
    s_waitcnt lgkmcnt(6)
    v_mfma_f32_16x16x32_bf16 v[148:151], v[204:207], a[176:179], v[148:151]
    ds_read_b64_tr_b16 v[188:189], v239 offset:8192
    v_mfma_f32_16x16x32_bf16 v[164:167], v[204:207], a[180:183], v[164:167]
    ds_read_b64_tr_b16 v[190:191], v239 offset:10240
    s_waitcnt lgkmcnt(6)
    v_mfma_f32_16x16x32_bf16 v[152:155], v[208:211], a[176:179], v[152:155]
    ds_read_b64_tr_b16 v[192:193], v240 offset:8192
    v_mfma_f32_16x16x32_bf16 v[168:171], v[208:211], a[180:183], v[168:171]
    ds_read_b64_tr_b16 v[194:195], v240 offset:10240
    s_waitcnt vmcnt(3)
    s_waitcnt lgkmcnt(6)
    v_mfma_f32_16x16x32_bf16 v[48:51], v[172:175], a[184:187], v[48:51]
    ds_read_b64_tr_b16 v[196:197], v45 offset:12288
    v_mfma_f32_16x16x32_bf16 v[156:159], v[172:175], a[188:191], v[156:159]
    ds_read_b64_tr_b16 v[198:199], v237 offset:12288
    s_waitcnt lgkmcnt(6)
    v_mfma_f32_16x16x32_bf16 v[56:59], v[176:179], a[184:187], v[56:59]
    ds_read_b64_tr_b16 v[200:201], v46 offset:12288
    v_mfma_f32_16x16x32_bf16 v[160:163], v[176:179], a[188:191], v[160:163]
    ds_read_b64_tr_b16 v[202:203], v238 offset:12288
    s_waitcnt lgkmcnt(6)
    v_mfma_f32_16x16x32_bf16 v[148:151], v[188:191], a[184:187], v[148:151]
    ds_read_b64_tr_b16 v[204:205], v47 offset:12288
    v_mfma_f32_16x16x32_bf16 v[164:167], v[188:191], a[188:191], v[164:167]
    ds_read_b64_tr_b16 v[206:207], v239 offset:12288
    s_waitcnt lgkmcnt(6)
    v_mfma_f32_16x16x32_bf16 v[152:155], v[192:195], a[184:187], v[152:155]
    ds_read_b64_tr_b16 v[208:209], v236 offset:12288
    v_mfma_f32_16x16x32_bf16 v[168:171], v[192:195], a[188:191], v[168:171]
    ds_read_b64_tr_b16 v[210:211], v240 offset:12288
    s_waitcnt vmcnt(2)
    v_swap_b32 v110, v112
    v_swap_b32 v111, v113
    s_waitcnt lgkmcnt(6)
    s_nop 0
    v_mfma_f32_16x16x32_bf16 v[48:51], v[196:199], v[108:111], v[48:51]
    v_mfma_f32_16x16x32_bf16 v[156:159], v[196:199], v[112:115], v[156:159]
    s_waitcnt lgkmcnt(4)
    v_mfma_f32_16x16x32_bf16 v[56:59], v[200:203], v[108:111], v[56:59]
    v_mfma_f32_16x16x32_bf16 v[160:163], v[200:203], v[112:115], v[160:163]
    s_waitcnt lgkmcnt(2)
    v_mfma_f32_16x16x32_bf16 v[148:151], v[204:207], v[108:111], v[148:151]
    v_mfma_f32_16x16x32_bf16 v[164:167], v[204:207], v[112:115], v[164:167]
    s_waitcnt lgkmcnt(0)
    v_mfma_f32_16x16x32_bf16 v[152:155], v[208:211], v[108:111], v[152:155]
    v_mfma_f32_16x16x32_bf16 v[168:171], v[208:211], v[112:115], v[168:171]
    s_waitcnt vmcnt(0)
    ds_read_b64_tr_b16 v[228:229], v12 offset:0
    ds_read_b64_tr_b16 v[230:231], v12 offset:1024
    ds_read_b64_tr_b16 v[232:233], v12 offset:32
    ds_read_b64_tr_b16 v[234:235], v12 offset:1056
    ds_write_b128 v13, v[148:151] offset:0
    s_nop 0
    ds_write_b128 v13, v[152:155] offset:1024
    ds_write_b128 v13, v[164:167] offset:2048
    ds_write_b128 v13, v[168:171] offset:3072
    v_pk_add_f32 v[116:117], v[116:117], v[48:49] op_sel:[0,0] op_sel_hi:[1,1]
    v_pk_add_f32 v[118:119], v[118:119], v[50:51] op_sel:[0,0] op_sel_hi:[1,1]
    v_pk_add_f32 v[120:121], v[120:121], v[56:57] op_sel:[0,0] op_sel_hi:[1,1]
    v_pk_add_f32 v[122:123], v[122:123], v[58:59] op_sel:[0,0] op_sel_hi:[1,1]
    v_pk_add_f32 v[124:125], v[124:125], v[156:157] op_sel:[0,0] op_sel_hi:[1,1]
    v_pk_add_f32 v[126:127], v[126:127], v[158:159] op_sel:[0,0] op_sel_hi:[1,1]
    v_pk_add_f32 v[128:129], v[128:129], v[160:161] op_sel:[0,0] op_sel_hi:[1,1]
    v_pk_add_f32 v[130:131], v[130:131], v[162:163] op_sel:[0,0] op_sel_hi:[1,1]
    s_waitcnt lgkmcnt(4)
    v_lshlrev_b32 v212, 16, v228
    v_and_b32 v213, 0xffff0000, v228
    v_lshlrev_b32 v214, 16, v229
    v_and_b32 v215, 0xffff0000, v229
    v_lshlrev_b32 v216, 16, v230
    v_and_b32 v217, 0xffff0000, v230
    v_lshlrev_b32 v218, 16, v231
    v_and_b32 v219, 0xffff0000, v231
    v_lshlrev_b32 v220, 16, v232
    v_and_b32 v221, 0xffff0000, v232
    v_lshlrev_b32 v222, 16, v233
    v_and_b32 v223, 0xffff0000, v233
    v_lshlrev_b32 v224, 16, v234
    v_and_b32 v225, 0xffff0000, v234
    v_lshlrev_b32 v226, 16, v235
    v_and_b32 v227, 0xffff0000, v235
    v_pk_mul_f32 v[212:213], v[212:213], v[132:133] op_sel:[0,0] op_sel_hi:[1,1]
    v_pk_mul_f32 v[214:215], v[214:215], v[134:135] op_sel:[0,0] op_sel_hi:[1,1]
    v_pk_mul_f32 v[216:217], v[216:217], v[136:137] op_sel:[0,0] op_sel_hi:[1,1]
    v_pk_mul_f32 v[218:219], v[218:219], v[138:139] op_sel:[0,0] op_sel_hi:[1,1]
    v_pk_mul_f32 v[220:221], v[220:221], v[140:141] op_sel:[0,0] op_sel_hi:[1,1]
    v_pk_mul_f32 v[222:223], v[222:223], v[142:143] op_sel:[0,0] op_sel_hi:[1,1]
    v_pk_mul_f32 v[224:225], v[224:225], v[144:145] op_sel:[0,0] op_sel_hi:[1,1]
    v_pk_mul_f32 v[226:227], v[226:227], v[146:147] op_sel:[0,0] op_sel_hi:[1,1]
    v_cvt_pk_bf16_f32 v228, v212, v213
    v_lshlrev_b32 v212, 16, v228
    v_and_b32 v213, 0xffff0000, v228
    v_cvt_pk_bf16_f32 v229, v214, v215
    v_lshlrev_b32 v214, 16, v229
    v_and_b32 v215, 0xffff0000, v229
    v_cvt_pk_bf16_f32 v230, v216, v217
    v_lshlrev_b32 v216, 16, v230
    v_and_b32 v217, 0xffff0000, v230
    v_cvt_pk_bf16_f32 v231, v218, v219
    v_lshlrev_b32 v218, 16, v231
    v_and_b32 v219, 0xffff0000, v231
    v_cvt_pk_bf16_f32 v232, v220, v221
    v_lshlrev_b32 v220, 16, v232
    v_and_b32 v221, 0xffff0000, v232
    v_cvt_pk_bf16_f32 v233, v222, v223
    v_lshlrev_b32 v222, 16, v233
    v_and_b32 v223, 0xffff0000, v233
    v_cvt_pk_bf16_f32 v234, v224, v225
    v_lshlrev_b32 v224, 16, v234
    v_and_b32 v225, 0xffff0000, v234
    v_cvt_pk_bf16_f32 v235, v226, v227
    v_lshlrev_b32 v226, 16, v235
    v_and_b32 v227, 0xffff0000, v235
    s_mov_b32 s48, 0xbfb8aa3b
    s_waitcnt lgkmcnt(0)
    s_barrier
    ds_read_b128 v[148:151], v14 offset:0
    ds_read_b128 v[152:155], v14 offset:1024
    ds_read_b128 v[164:167], v14 offset:2048
    ds_read_b128 v[168:171], v14 offset:3072
    s_waitcnt lgkmcnt(2)
    v_pk_add_f32 v[116:117], v[116:117], v[148:149] op_sel:[0,0] op_sel_hi:[1,1]
    v_pk_add_f32 v[118:119], v[118:119], v[150:151] op_sel:[0,0] op_sel_hi:[1,1]
    v_pk_add_f32 v[120:121], v[120:121], v[152:153] op_sel:[0,0] op_sel_hi:[1,1]
    v_pk_add_f32 v[122:123], v[122:123], v[154:155] op_sel:[0,0] op_sel_hi:[1,1]
    v_pk_mul_f32 v[84:85], v[116:117], s[48:49] op_sel:[0,0] op_sel_hi:[1,0]
    v_pk_mul_f32 v[86:87], v[118:119], s[48:49] op_sel:[0,0] op_sel_hi:[1,0]
    v_pk_mul_f32 v[88:89], v[120:121], s[48:49] op_sel:[0,0] op_sel_hi:[1,0]
    v_pk_mul_f32 v[90:91], v[122:123], s[48:49] op_sel:[0,0] op_sel_hi:[1,0]
    v_exp_f32 v84, v84
    v_exp_f32 v85, v85
    v_exp_f32 v86, v86
    v_exp_f32 v87, v87
    v_exp_f32 v88, v88
    v_exp_f32 v89, v89
    v_exp_f32 v90, v90
    v_exp_f32 v91, v91
    v_pk_add_f32 v[84:85], v[84:85], 1.0 op_sel:[0,0] op_sel_hi:[1,0]
    v_pk_add_f32 v[86:87], v[86:87], 1.0 op_sel:[0,0] op_sel_hi:[1,0]
    v_pk_add_f32 v[88:89], v[88:89], 1.0 op_sel:[0,0] op_sel_hi:[1,0]
    v_pk_add_f32 v[90:91], v[90:91], 1.0 op_sel:[0,0] op_sel_hi:[1,0]
    v_rcp_f32 v84, v84
    v_rcp_f32 v85, v85
    v_rcp_f32 v86, v86
    v_rcp_f32 v87, v87
    v_rcp_f32 v88, v88
    v_rcp_f32 v89, v89
    v_rcp_f32 v90, v90
    v_rcp_f32 v91, v91
    v_pk_mul_f32 v[116:117], v[116:117], v[212:213] op_sel:[0,0] op_sel_hi:[1,1]
    v_pk_mul_f32 v[118:119], v[118:119], v[214:215] op_sel:[0,0] op_sel_hi:[1,1]
    v_pk_mul_f32 v[120:121], v[120:121], v[216:217] op_sel:[0,0] op_sel_hi:[1,1]
    v_pk_mul_f32 v[122:123], v[122:123], v[218:219] op_sel:[0,0] op_sel_hi:[1,1]
    v_pk_fma_f32 v[84:85], v[84:85], v[116:117], v[28:29] op_sel:[0,0,0] op_sel_hi:[1,1,1]
    v_pk_fma_f32 v[86:87], v[86:87], v[118:119], v[30:31] op_sel:[0,0,0] op_sel_hi:[1,1,1]
    v_pk_fma_f32 v[88:89], v[88:89], v[120:121], v[32:33] op_sel:[0,0,0] op_sel_hi:[1,1,1]
    v_pk_fma_f32 v[90:91], v[90:91], v[122:123], v[34:35] op_sel:[0,0,0] op_sel_hi:[1,1,1]
    v_cvt_pk_bf16_f32 v100, v84, v85
    v_cvt_pk_bf16_f32 v101, v86, v87
    v_cvt_pk_bf16_f32 v102, v88, v89
    v_cvt_pk_bf16_f32 v103, v90, v91
    s_nop 0
    v_permlane16_swap_b32 v100, v102
    v_permlane16_swap_b32 v101, v103
    buffer_store_dwordx4 v[100:103], v44, s[40:43], 0 offen offset:0
    s_waitcnt lgkmcnt(0)
    v_pk_add_f32 v[124:125], v[124:125], v[164:165] op_sel:[0,0] op_sel_hi:[1,1]
    v_pk_add_f32 v[126:127], v[126:127], v[166:167] op_sel:[0,0] op_sel_hi:[1,1]
    v_pk_add_f32 v[128:129], v[128:129], v[168:169] op_sel:[0,0] op_sel_hi:[1,1]
    v_pk_add_f32 v[130:131], v[130:131], v[170:171] op_sel:[0,0] op_sel_hi:[1,1]
    v_pk_mul_f32 v[92:93], v[124:125], s[48:49] op_sel:[0,0] op_sel_hi:[1,0]
    v_pk_mul_f32 v[94:95], v[126:127], s[48:49] op_sel:[0,0] op_sel_hi:[1,0]
    v_pk_mul_f32 v[96:97], v[128:129], s[48:49] op_sel:[0,0] op_sel_hi:[1,0]
    v_pk_mul_f32 v[98:99], v[130:131], s[48:49] op_sel:[0,0] op_sel_hi:[1,0]
    v_exp_f32 v92, v92
    v_exp_f32 v93, v93
    v_exp_f32 v94, v94
    v_exp_f32 v95, v95
    v_exp_f32 v96, v96
    v_exp_f32 v97, v97
    v_exp_f32 v98, v98
    v_exp_f32 v99, v99
    v_pk_add_f32 v[92:93], v[92:93], 1.0 op_sel:[0,0] op_sel_hi:[1,0]
    v_pk_add_f32 v[94:95], v[94:95], 1.0 op_sel:[0,0] op_sel_hi:[1,0]
    v_pk_add_f32 v[96:97], v[96:97], 1.0 op_sel:[0,0] op_sel_hi:[1,0]
    v_pk_add_f32 v[98:99], v[98:99], 1.0 op_sel:[0,0] op_sel_hi:[1,0]
    v_rcp_f32 v92, v92
    v_rcp_f32 v93, v93
    v_rcp_f32 v94, v94
    v_rcp_f32 v95, v95
    v_rcp_f32 v96, v96
    v_rcp_f32 v97, v97
    v_rcp_f32 v98, v98
    v_rcp_f32 v99, v99
    v_pk_mul_f32 v[124:125], v[124:125], v[220:221] op_sel:[0,0] op_sel_hi:[1,1]
    v_pk_mul_f32 v[126:127], v[126:127], v[222:223] op_sel:[0,0] op_sel_hi:[1,1]
    v_pk_mul_f32 v[128:129], v[128:129], v[224:225] op_sel:[0,0] op_sel_hi:[1,1]
    v_pk_mul_f32 v[130:131], v[130:131], v[226:227] op_sel:[0,0] op_sel_hi:[1,1]
    v_pk_fma_f32 v[92:93], v[92:93], v[124:125], v[36:37] op_sel:[0,0,0] op_sel_hi:[1,1,1]
    v_pk_fma_f32 v[94:95], v[94:95], v[126:127], v[38:39] op_sel:[0,0,0] op_sel_hi:[1,1,1]
    v_pk_fma_f32 v[96:97], v[96:97], v[128:129], v[40:41] op_sel:[0,0,0] op_sel_hi:[1,1,1]
    v_pk_fma_f32 v[98:99], v[98:99], v[130:131], v[42:43] op_sel:[0,0,0] op_sel_hi:[1,1,1]
    v_cvt_pk_bf16_f32 v104, v92, v93
    v_cvt_pk_bf16_f32 v105, v94, v95
    v_cvt_pk_bf16_f32 v106, v96, v97
    v_cvt_pk_bf16_f32 v107, v98, v99
    s_nop 0
    v_permlane16_swap_b32 v104, v106
    v_permlane16_swap_b32 v105, v107
    buffer_store_dwordx4 v[104:107], v44, s[40:43], 0 offen offset:1024
L_end:
    s_endpgm
.section .rodata,"a"
.p2align 6
.amdhsa_kernel recurrent_scan__ssm_conv_h3__mixer_s_mlp__prompt_kernel
  .amdhsa_next_free_vgpr 512
  .amdhsa_next_free_sgpr 102
  .amdhsa_accum_offset 256
  .amdhsa_group_segment_fixed_size 0
  .amdhsa_kernarg_size 112
  .amdhsa_user_sgpr_count 2
  .amdhsa_user_sgpr_kernarg_segment_ptr 1
  .amdhsa_system_sgpr_workgroup_id_x 1
.end_amdhsa_kernel
```
